```python
import torch

def _softmax(x, axis=-1):
    return torch.softmax(x, dim=axis)
def _gelu(x):
    return torch.nn.functional.gelu(x, approximate="tanh")
def _silu(x):
    return torch.nn.functional.silu(x)
def _sigmoid(x):
    return torch.sigmoid(x)
def _layernorm(x, axis=-1, eps=1e-5):
    m = x.mean(dim=axis, keepdim=True)
    v = x.var(dim=axis, keepdim=True, unbiased=False)
    return (x - m) / torch.sqrt(v + eps)
def _scatter_add(tgt, idx, src, axis=0):
    return tgt.clone().index_add_(axis, idx, src)
def _segment_sum(src, seg, n):
    out = torch.zeros((n,) + src.shape[1:], dtype=src.dtype)
    return out.index_add_(0, seg, src)
def _pad(x, pw):
    flat = tuple(v for pair in reversed(pw) for v in pair)
    return torch.nn.functional.pad(x, flat)

kernel_name = 'standalone__weight_only_int_gptq__prompt'

def setup_inputs():

    _w = (lambda a: (lambda t: t.to(torch.bfloat16) if t.is_floating_point() else t)(torch.as_tensor(a)))
    B, S, D, F = 1, 2048, 1024, 3584
    bits = max(2, min(4, 4))
    pf = 32 // bits
    G = 64 if 64 > 0 else D
    G = max(pf, (G // pf) * pf)
    D = max(G, (D // G) * G)
    ng = D // G
    qmax = 1 << bits
    qw = torch.randint(0, qmax, (D, F)).to(torch.int64)
    packed = torch.zeros((D // pf, F), dtype=torch.int64)
    for i in range(pf):
        packed |= (qw[i::pf] << (i * bits))
    packed = packed.to(torch.int32)
    return {
        "x": _w((lambda *s: torch.randn(*s, dtype=torch.bfloat16) * 0.05)(B, S, D)),
        "qw_packed": _w(packed),
        "scales": _w(torch.abs((lambda *s: torch.randn(*s, dtype=torch.bfloat16) * 0.05)(ng, F)).to(float) * 0.1 + 0.01),
        "zeros": _w(torch.randint(0, qmax, (ng, F)).to(float)),
        "bits": _w((lambda _x: torch.as_tensor(_x, dtype=torch.int32))(bits)),
    }

def reference(x, qw_packed, scales, zeros, bits):
    b = int(bits)
    pf = 32 // b
    mask = (1 << b) - 1
    P, F = qw_packed.shape
    D = P * pf
    ng = scales.shape[0]
    G = D // ng
    shifts = (lambda x, dt: x.to(dt))(torch.arange(pf) * b, qw_packed.dtype)
    qw = ((qw_packed[:, None, :] >> shifts[None, :, None]) & mask).reshape(D, F)
    s = (lambda x, n, axis: torch.repeat_interleave(x, n, dim=axis))(scales, G, axis=0)
    z = (lambda x, n, axis: torch.repeat_interleave(x, n, dim=axis))(zeros, G, axis=0)
    w = ((lambda x, dt: x.to(dt))(qw, x.dtype) - z) * s
    return torch.einsum("bsd,df->bsf", x, w)
```

```asm
; @launch grid=(256,1,1) block=(512,1,1) lds=163840
.amdgcn_target "amdgcn-amd-amdhsa--gfx950"
.text
.globl standalone__weight_only_int_gptq__prompt_kernel
.p2align 12
.type standalone__weight_only_int_gptq__prompt_kernel,@function
standalone__weight_only_int_gptq__prompt_kernel:
    s_getpc_b64 s[60:61]
L_pc:
    v_mul_u32_u24 v96, 32, v0
    v_add_co_u32 v96, vcc, s60, v96
    v_mov_b32 v97, s61
    v_addc_co_u32 v97, vcc, 0, v97, vcc
    global_load_dword v98, v[96:97], off offset:-4
    s_load_dwordx2 s[4:5], s[0:1], 0
    s_load_dwordx2 s[8:9], s[0:1], 8
    s_load_dwordx2 s[12:13], s[0:1], 16
    s_load_dwordx2 s[16:17], s[0:1], 24
    s_load_dwordx2 s[20:21], s[0:1], 40
    v_lshrrev_b32 v1, 6, v0
    v_and_b32 v0, 63, v0
    s_and_b32 s30, s2, 7
    s_lshr_b32 s31, s2, 3
    v_readfirstlane_b32 s24, v1
    s_lshl_b32 s32, s30, 1
    s_lshr_b32 s32, 0xafdf, s32
    s_and_b32 s32, s32, 3
    s_add_u32 s32, s32, 29
    s_cmp_ge_u32 s31, s32
    s_cbranch_scc1 L_end
    s_mov_b32 s26, 0x5e009fbf
    s_mov_b32 s27, 0xdf801e3e
    s_lshl_b32 s30, s30, 3
    s_lshr_b64 s[26:27], s[26:27], s30
    s_bfe_u32 s32, s26, 0x10007
    s_and_b32 s30, s26, 0x7f
    s_add_u32 s30, s30, s31
    s_mul_i32 s27, s30, 4682
    s_lshr_b32 s27, s27, 16
    s_sub_u32 s32, s32, s27
    s_mul_i32 s32, s32, 14
    s_add_u32 s26, s30, s32
    s_sub_u32 s27, 8, s27
    s_mul_i32 s28, s27, 14
    s_lshr_b32 s31, s27, 3
    s_add_u32 s28, s28, s31
    s_bitcmp1_b32 s26, 0
    s_cselect_b32 s29, 7, 0
    s_and_b32 s25, s24, 3
    v_and_b32 v72, 15, v0
    v_lshrrev_b32 v73, 4, v0
    s_cmp_ge_u32 s24, 4
    s_cbranch_scc0 L_mainp
L_helper:
    s_setprio 2
    s_and_b32 s30, s25, 1
    s_lshl_b32 s30, s30, 2
    v_and_b32 v5, 7, v0
    v_xor_b32 v5, v5, v73
    v_xor_b32 v5, s30, v5
    v_lshlrev_b32 v5, 4, v5
    v_lshrrev_b32 v6, 3, v0
    v_lshl_add_u32 v10, v6, 11, v5
    s_mov_b32 s6, 0x400000
    s_mov_b32 s7, 0x00020000
    s_lshl_b32 s40, s28, 15
    s_lshl_b32 s30, s25, 14
    s_add_u32 s40, s40, s30
    s_mov_b32 s41, 0
    s_add_u32 s48, s29, 2
    s_mul_i32 s49, s48, 114688
    s_lshl_b32 s48, s48, 7
    s_lshl_b32 s30, s25, 10
    s_add_u32 s47, s30, 133120
    s_mov_b32 s42, s47
    v_lshrrev_b32 v5, 5, v0
    v_mul_u32_u24 v5, 14336, v5
    v_and_b32 v6, 31, v0
    v_lshl_add_u32 v5, v6, 4, v5
    s_mul_i32 s31, s25, 28672
    s_lshl_b32 s32, s26, 9
    s_add_u32 s31, s31, s32
    v_add_u32 v11, s31, v5
    s_mov_b32 s43, 114688
    s_add_u32 s44, s30, 4096
    s_mov_b32 s10, 1835008
    s_mov_b32 s11, 0x00020000
    s_mov_b64 vcc, 0
    s_cmp_ge_u32 s27, 7
    s_cselect_b32 s45, 2, 0
    s_cmp_lt_u32 s25, s45
    s_cselect_b32 s45, 1, 0
    s_waitcnt lgkmcnt(0)
    s_call_b64 s[50:51], L_issue
    s_branch L_h2
L_issue:
    s_add_u32 s46, s40, s41
    s_cmp_eq_u32 s45, 0
    s_cbranch_scc1 L_i7
    s_add_u32 m0, s42, 28672
    s_add_u32 s32, s46, 458752
    buffer_load_dwordx4 v10, s[4:7], s32 offen lds
L_i7:
    s_mov_b32 m0, s42
    s_add_u32 s41, s41, 128
    buffer_load_dwordx4 v10, s[4:7], s46 offen lds
    s_add_u32 m0, m0, 4096
    s_add_u32 s46, s46, 65536
    buffer_load_dwordx4 v10, s[4:7], s46 offen lds
    s_add_u32 m0, m0, 4096
    s_add_u32 s46, s46, 65536
    buffer_load_dwordx4 v10, s[4:7], s46 offen lds
    s_add_u32 m0, m0, 4096
    s_add_u32 s46, s46, 65536
    buffer_load_dwordx4 v10, s[4:7], s46 offen lds
    s_add_u32 m0, m0, 4096
    s_add_u32 s46, s46, 65536
    buffer_load_dwordx4 v10, s[4:7], s46 offen lds
    s_add_u32 m0, m0, 4096
    s_add_u32 s46, s46, 65536
    buffer_load_dwordx4 v10, s[4:7], s46 offen lds
    s_add_u32 m0, m0, 4096
    s_add_u32 s46, s46, 65536
    buffer_load_dwordx4 v10, s[4:7], s46 offen lds
    s_mov_b32 m0, s44
    s_cmp_eq_u32 s41, 256
    buffer_load_dwordx4 v11, s[8:11], s43 offen lds
    s_cselect_b32 s41, s48, s41
    s_cmp_eq_u32 s41, 2048
    s_cselect_b32 s41, 256, s41
    s_add_u32 s43, s43, 114688
    s_cmp_eq_u32 s43, 229376
    s_cselect_b32 s43, s49, s43
    s_cmp_eq_u32 s43, 1835008
    s_cselect_b32 s43, 229376, s43
    s_add_u32 s44, s44, 4096
    s_and_b32 s44, s44, 16383
    s_sub_u32 s42, s42, 30720
    s_cmp_lt_u32 s42, 40960
    s_cselect_b32 s42, s47, s42
L_iret:
    s_setpc_b64 s[50:51]
L_mainp:
    s_setprio 3
    s_lshl_b32 s30, s25, 4
    v_add_u32 v74, s30, v72
    s_lshl_b32 s33, s26, 8
    v_mul_u32_u24 v75, 14336, v73
    v_lshl_add_u32 v88, v74, 2, s33
    v_lshl_add_u32 v75, v88, 1, v75
    v_add_u32 v76, 57344, v75
    s_add_i32 s30, s29, -2
    v_add_u32 v77, s30, v73
    v_subrev_u32 v78, 14, v77
    v_min_u32 v77, v77, v78
    v_add_u32 v77, 2, v77
    v_add_u32 v78, 0, v73
    v_cmp_gt_u32 vcc, 2, v78
    v_cndmask_b32 v77, v77, v78, vcc
    v_mul_u32_u24 v77, 7168, v77
    v_add_u32 v77, v88, v77
    s_mov_b32 s10, 1835008
    s_mov_b32 s11, 0x00020000
    s_mov_b32 s14, 114688
    s_mov_b32 s15, 0x00020000
    s_mov_b32 s18, 114688
    s_mov_b32 s19, 0x00020000
    s_mov_b32 s47, 0
    s_mov_b32 s31, 7168
    s_add_u32 s30, s29, 13
    s_sub_u32 s32, s30, 14
    s_cmp_ge_u32 s30, 16
    s_cselect_b32 s30, s32, s30
    s_mul_i32 s44, s30, 114688
    s_add_i32 s30, s29, 2
    v_add_u32 v90, s30, v73
    v_subrev_u32 v78, 14, v90
    v_min_u32 v90, v90, v78
    v_add_u32 v90, 2, v90
    v_mad_u32_u24 v90, v90, s31, v88
    s_add_u32 s30, s29, 14
    s_sub_u32 s32, s30, 14
    s_cmp_ge_u32 s30, 16
    s_cselect_b32 s30, s32, s30
    s_mul_i32 s45, s30, 114688
    s_add_i32 s30, s29, 6
    v_add_u32 v91, s30, v73
    v_subrev_u32 v78, 14, v91
    v_min_u32 v91, v91, v78
    v_add_u32 v91, 2, v91
    v_mad_u32_u24 v91, v91, s31, v88
    s_add_u32 s30, s29, 15
    s_sub_u32 s32, s30, 14
    s_cmp_ge_u32 s30, 16
    s_cselect_b32 s30, s32, s30
    s_mul_i32 s46, s30, 114688
    s_add_i32 s30, s29, 10
    v_add_u32 v92, s30, v73
    v_subrev_u32 v78, 14, v92
    v_min_u32 v92, v92, v78
    v_add_u32 v92, 2, v92
    v_mad_u32_u24 v92, v92, s31, v88
    s_waitcnt lgkmcnt(0)
    buffer_load_dword v8, v77, s[12:15], 0 offen
    buffer_load_dword v9, v77, s[16:19], 0 offen
    buffer_load_dword v10, v92, s[12:15], 0 offen
    buffer_load_dword v11, v92, s[16:19], 0 offen
    buffer_load_dwordx2 v[56:57], v75, s[8:11], s47 offen
    buffer_load_dwordx2 v[58:59], v76, s[8:11], s47 offen
    buffer_load_dwordx2 v[116:117], v75, s[8:11], s46 offen
    buffer_load_dwordx2 v[118:119], v76, s[8:11], s46 offen
    buffer_load_dword v12, v90, s[12:15], 0 offen
    buffer_load_dword v13, v90, s[16:19], 0 offen
    buffer_load_dword v14, v91, s[12:15], 0 offen
    buffer_load_dword v15, v91, s[16:19], 0 offen
    buffer_load_dwordx2 v[100:101], v75, s[8:11], s45 offen
    buffer_load_dwordx2 v[102:103], v76, s[8:11], s45 offen
    buffer_load_dwordx2 v[84:85], v75, s[8:11], s44 offen
    buffer_load_dwordx2 v[86:87], v76, s[8:11], s44 offen
    v_mov_b32 v40, 0
    v_mov_b32 v41, 0
    v_mov_b32 v42, 0
    v_mov_b32 v43, 0
    s_mov_b32 s34, 0x000f000f
    s_mov_b32 s35, 0x00f000f0
    s_mov_b32 s22, 14680064
    s_mov_b32 s23, 0x00020000
    v_mfma_f32_32x32x16_bf16 v[136:151], v[40:43], v[40:43], 0
    v_lshrrev_b32 v78, 1, v72
    v_xor_b32 v78, v78, v73
    v_lshlrev_b32 v78, 4, v78
    v_mfma_f32_32x32x16_bf16 v[152:167], v[40:43], v[40:43], 0
    v_lshl_add_u32 v78, v72, 7, v78
    v_add_u32 v2, 102400, v78
    v_xor_b32 v3, 64, v2
    v_mfma_f32_32x32x16_bf16 v[168:183], v[40:43], v[40:43], 0
    s_mov_b32 s37, -61440
    v_lshlrev_b32 v78, 9, v73
    v_lshl_add_u32 v4, v74, 3, v78
    v_mfma_f32_32x32x16_bf16 v[184:199], v[40:43], v[40:43], 0
    v_lshlrev_b32 v5, 4, v74
    v_add_u32 v5, 36352, v5
    v_lshlrev_b32 v6, 3, v74
    v_mfma_f32_32x32x16_bf16 v[200:215], v[40:43], v[40:43], 0
    v_add_u32 v6, 37376, v6
    v_mul_u32_u24 v78, 28672, v73
    v_lshl_add_u32 v78, v72, 2, v78
    v_mfma_f32_32x32x16_bf16 v[216:231], v[40:43], v[40:43], 0
    s_lshl_b32 s30, s25, 6
    s_add_u32 s30, s30, s33
    v_add_u32 v7, s30, v78
    v_mul_u32_u24 v78, 1536, v73
    v_add_u32 v78, 15360, v78
    v_sub_u32 v79, v5, v78
    v_sub_u32 v89, v6, v78
    v_mfma_f32_32x32x16_bf16 v[232:247], v[40:43], v[40:43], 0
    s_mul_i32 s38, s28, 114688
    s_sub_u32 s40, s38, 114688
    s_mov_b32 s36, 5
    v_mfma_f32_32x32x16_bf16 v[240:255], v[40:43], v[40:43], 0
    v_add_u32 v0, -69632, v2
    v_add_u32 v1, -69632, v3
    s_waitcnt vmcnt(14)
    v_lshlrev_b32 v68, 16, v8
    v_and_b32 v69, 0xffff0000, v8
    v_lshlrev_b32_e64 v70, 16, v9
    v_and_b32 v71, 0xffff0000, v9
    v_mul_f32 v16, 0x4b800000, v68
    v_mul_f32 v17, 0x49800000, v68
    v_mul_f32 v18, 0x4b800000, v69
    v_mul_f32 v19, 0x49800000, v69
    v_mul_f32_e64 v20, -v70, v68
    v_mul_f32_e64 v21, -v71, v69
    ds_write_b128 v79, v[16:19] offset:18432
    ds_write_b64 v89, v[20:21] offset:18432
    ds_read_b128 v[60:63], v5 offset:3072
    ds_read_b64 v[64:65], v6 offset:3072
    v_subrev_u32 v8, 19968, v5
    v_subrev_u32 v9, 19968, v6
    s_waitcnt vmcnt(12)
    v_lshlrev_b32 v68, 16, v10
    v_and_b32 v69, 0xffff0000, v10
    v_lshlrev_b32_e64 v70, 16, v11
    v_and_b32 v71, 0xffff0000, v11
    v_mul_f32 v24, 0x4b800000, v68
    v_mul_f32 v25, 0x49800000, v68
    v_mul_f32 v26, 0x4b800000, v69
    v_mul_f32 v27, 0x49800000, v69
    v_mul_f32_e64 v22, -v70, v68
    v_mul_f32_e64 v23, -v71, v69
    ds_write_b128 v79, v[24:27] offset:0
    ds_write_b64 v89, v[22:23] offset:0
    ds_read_b128 v[36:39], v8 offset:0
    ds_read_b64 v[34:35], v9 offset:0
    ds_read_b128 v[40:43], v8 offset:1536
    ds_read_b64 v[44:45], v9 offset:1536
    ds_read_b128 v[52:55], v8 offset:3072
    ds_read_b64 v[66:67], v9 offset:3072
    s_waitcnt vmcnt(10) lgkmcnt(8)
    v_and_b32 v68, s34, v56
    v_and_b32 v69, s35, v56
    v_lshrrev_b32 v56, 8, v56
    v_fma_mix_f32 v120, v68, v60, v64 op_sel:[0,0,0] op_sel_hi:[1,0,0]
    v_fma_mix_f32 v70, v69, v61, v64 op_sel:[0,0,0] op_sel_hi:[1,0,0]
    v_fma_mix_f32 v122, v68, v60, v64 op_sel:[1,0,0] op_sel_hi:[1,0,0]
    v_fma_mix_f32 v71, v69, v61, v64 op_sel:[1,0,0] op_sel_hi:[1,0,0]
    v_and_b32 v68, s34, v56
    v_and_b32 v69, s35, v56
    v_cvt_pk_bf16_f32 v120, v120, v70
    v_cvt_pk_bf16_f32 v122, v122, v71
    v_fma_mix_f32 v121, v68, v60, v64 op_sel:[0,0,0] op_sel_hi:[1,0,0]
    v_fma_mix_f32 v70, v69, v61, v64 op_sel:[0,0,0] op_sel_hi:[1,0,0]
    v_fma_mix_f32 v123, v68, v60, v64 op_sel:[1,0,0] op_sel_hi:[1,0,0]
    v_fma_mix_f32 v71, v69, v61, v64 op_sel:[1,0,0] op_sel_hi:[1,0,0]
    v_cvt_pk_bf16_f32 v121, v121, v70
    v_cvt_pk_bf16_f32 v123, v123, v71
    v_and_b32 v68, s34, v57
    v_and_b32 v69, s35, v57
    v_lshrrev_b32_e64 v57, 8, v57
    v_fma_mix_f32 v124, v68, v62, v65 op_sel:[0,0,0] op_sel_hi:[1,0,0]
    v_fma_mix_f32 v70, v69, v63, v65 op_sel:[0,0,0] op_sel_hi:[1,0,0]
    v_fma_mix_f32 v126, v68, v62, v65 op_sel:[1,0,0] op_sel_hi:[1,0,0]
    v_fma_mix_f32 v71, v69, v63, v65 op_sel:[1,0,0] op_sel_hi:[1,0,0]
    v_and_b32 v68, s34, v57
    v_and_b32 v69, s35, v57
    v_cvt_pk_bf16_f32 v124, v124, v70
    v_cvt_pk_bf16_f32 v126, v126, v71
    v_fma_mix_f32 v125, v68, v62, v65 op_sel:[0,0,0] op_sel_hi:[1,0,0]
    v_fma_mix_f32 v70, v69, v63, v65 op_sel:[0,0,0] op_sel_hi:[1,0,0]
    v_fma_mix_f32 v127, v68, v62, v65 op_sel:[1,0,0] op_sel_hi:[1,0,0]
    v_fma_mix_f32 v71, v69, v63, v65 op_sel:[1,0,0] op_sel_hi:[1,0,0]
    v_cvt_pk_bf16_f32 v125, v125, v70
    v_cvt_pk_bf16_f32 v127, v127, v71
    s_waitcnt vmcnt(8) lgkmcnt(4)
    v_and_b32 v68, s34, v116
    v_and_b32 v69, s35, v116
    v_lshrrev_b32 v116, 8, v116
    v_fma_mix_f32 v104, v68, v36, v34 op_sel:[0,0,0] op_sel_hi:[1,0,0]
    v_fma_mix_f32 v70, v69, v37, v34 op_sel:[0,0,0] op_sel_hi:[1,0,0]
    v_fma_mix_f32 v106, v68, v36, v34 op_sel:[1,0,0] op_sel_hi:[1,0,0]
    v_fma_mix_f32 v71, v69, v37, v34 op_sel:[1,0,0] op_sel_hi:[1,0,0]
    v_and_b32 v68, s34, v116
    v_and_b32 v69, s35, v116
    v_cvt_pk_bf16_f32 v104, v104, v70
    v_cvt_pk_bf16_f32 v106, v106, v71
    v_fma_mix_f32 v105, v68, v36, v34 op_sel:[0,0,0] op_sel_hi:[1,0,0]
    v_fma_mix_f32 v70, v69, v37, v34 op_sel:[0,0,0] op_sel_hi:[1,0,0]
    v_fma_mix_f32 v107, v68, v36, v34 op_sel:[1,0,0] op_sel_hi:[1,0,0]
    v_fma_mix_f32 v71, v69, v37, v34 op_sel:[1,0,0] op_sel_hi:[1,0,0]
    v_cvt_pk_bf16_f32 v105, v105, v70
    v_cvt_pk_bf16_f32 v107, v107, v71
    v_and_b32 v68, s34, v117
    v_and_b32 v69, s35, v117
    v_lshrrev_b32_e64 v117, 8, v117
    v_fma_mix_f32 v108, v68, v38, v35 op_sel:[0,0,0] op_sel_hi:[1,0,0]
    v_fma_mix_f32 v70, v69, v39, v35 op_sel:[0,0,0] op_sel_hi:[1,0,0]
    v_fma_mix_f32 v110, v68, v38, v35 op_sel:[1,0,0] op_sel_hi:[1,0,0]
    v_fma_mix_f32 v71, v69, v39, v35 op_sel:[1,0,0] op_sel_hi:[1,0,0]
    v_and_b32 v68, s34, v117
    v_and_b32 v69, s35, v117
    v_cvt_pk_bf16_f32 v108, v108, v70
    v_cvt_pk_bf16_f32 v110, v110, v71
    v_fma_mix_f32 v109, v68, v38, v35 op_sel:[0,0,0] op_sel_hi:[1,0,0]
    v_fma_mix_f32 v70, v69, v39, v35 op_sel:[0,0,0] op_sel_hi:[1,0,0]
    v_fma_mix_f32 v111, v68, v38, v35 op_sel:[1,0,0] op_sel_hi:[1,0,0]
    v_fma_mix_f32 v71, v69, v39, v35 op_sel:[1,0,0] op_sel_hi:[1,0,0]
    v_cvt_pk_bf16_f32 v109, v109, v70
    v_cvt_pk_bf16_f32 v111, v111, v71
    v_and_b32 v68, s34, v118
    v_and_b32 v69, s35, v118
    v_lshrrev_b32_e64 v118, 8, v118
    v_fma_mix_f32 v112, v68, v36, v34 op_sel:[0,0,0] op_sel_hi:[1,0,0]
    v_fma_mix_f32 v70, v69, v37, v34 op_sel:[0,0,0] op_sel_hi:[1,0,0]
    v_fma_mix_f32 v114, v68, v36, v34 op_sel:[1,0,0] op_sel_hi:[1,0,0]
    v_fma_mix_f32 v71, v69, v37, v34 op_sel:[1,0,0] op_sel_hi:[1,0,0]
    v_and_b32 v68, s34, v118
    v_and_b32 v69, s35, v118
    v_cvt_pk_bf16_f32 v112, v112, v70
    v_cvt_pk_bf16_f32 v114, v114, v71
    v_fma_mix_f32 v113, v68, v36, v34 op_sel:[0,0,0] op_sel_hi:[1,0,0]
    v_fma_mix_f32 v70, v69, v37, v34 op_sel:[0,0,0] op_sel_hi:[1,0,0]
    v_fma_mix_f32 v115, v68, v36, v34 op_sel:[1,0,0] op_sel_hi:[1,0,0]
    v_fma_mix_f32 v71, v69, v37, v34 op_sel:[1,0,0] op_sel_hi:[1,0,0]
    v_cvt_pk_bf16_f32 v113, v113, v70
    v_cvt_pk_bf16_f32 v115, v115, v71
    v_and_b32 v68, s34, v119
    v_and_b32 v69, s35, v119
    v_lshrrev_b32_e64 v119, 8, v119
    v_fma_mix_f32 v116, v68, v38, v35 op_sel:[0,0,0] op_sel_hi:[1,0,0]
    v_fma_mix_f32 v70, v69, v39, v35 op_sel:[0,0,0] op_sel_hi:[1,0,0]
    v_fma_mix_f32 v118, v68, v38, v35 op_sel:[1,0,0] op_sel_hi:[1,0,0]
    v_fma_mix_f32 v71, v69, v39, v35 op_sel:[1,0,0] op_sel_hi:[1,0,0]
    v_and_b32 v68, s34, v119
    v_and_b32 v69, s35, v119
    v_cvt_pk_bf16_f32 v116, v116, v70
    v_cvt_pk_bf16_f32 v118, v118, v71
    v_fma_mix_f32 v117, v68, v38, v35 op_sel:[0,0,0] op_sel_hi:[1,0,0]
    v_fma_mix_f32 v70, v69, v39, v35 op_sel:[0,0,0] op_sel_hi:[1,0,0]
    v_fma_mix_f32 v119, v68, v38, v35 op_sel:[1,0,0] op_sel_hi:[1,0,0]
    v_fma_mix_f32 v71, v69, v39, v35 op_sel:[1,0,0] op_sel_hi:[1,0,0]
    v_cvt_pk_bf16_f32 v117, v117, v70
    v_cvt_pk_bf16_f32 v119, v119, v71
    s_waitcnt vmcnt(6)
    v_lshlrev_b32 v68, 16, v12
    v_and_b32 v69, 0xffff0000, v12
    v_lshlrev_b32_e64 v70, 16, v13
    v_and_b32 v71, 0xffff0000, v13
    v_mul_f32 v16, 0x4b800000, v68
    v_mul_f32 v17, 0x49800000, v68
    v_mul_f32 v18, 0x4b800000, v69
    v_mul_f32 v19, 0x49800000, v69
    v_mul_f32_e64 v20, -v70, v68
    v_mul_f32_e64 v21, -v71, v69
    ds_write_b128 v79, v[16:19] offset:12288
    ds_write_b64 v89, v[20:21] offset:12288
    s_waitcnt vmcnt(4)
    v_lshlrev_b32_e64 v68, 16, v14
    v_and_b32 v69, 0xffff0000, v14
    v_lshlrev_b32 v70, 16, v15
    v_and_b32 v71, 0xffff0000, v15
    v_mul_f32 v28, 0x4b800000, v68
    v_mul_f32 v29, 0x49800000, v68
    v_mul_f32 v30, 0x4b800000, v69
    v_mul_f32 v31, 0x49800000, v69
    v_mul_f32_e64 v32, -v70, v68
    v_mul_f32_e64 v33, -v71, v69
    ds_write_b128 v79, v[28:31] offset:6144
    ds_write_b64 v89, v[32:33] offset:6144
    s_waitcnt vmcnt(2) lgkmcnt(4)
    v_and_b32 v68, s34, v100
    v_and_b32 v69, s35, v100
    v_lshrrev_b32 v100, 8, v100
    v_fma_mix_f32 v88, v68, v40, v44 op_sel:[0,0,0] op_sel_hi:[1,0,0]
    v_fma_mix_f32 v70, v69, v41, v44 op_sel:[0,0,0] op_sel_hi:[1,0,0]
    v_fma_mix_f32 v90, v68, v40, v44 op_sel:[1,0,0] op_sel_hi:[1,0,0]
    v_fma_mix_f32 v71, v69, v41, v44 op_sel:[1,0,0] op_sel_hi:[1,0,0]
    v_and_b32 v68, s34, v100
    v_and_b32 v69, s35, v100
    v_cvt_pk_bf16_f32 v88, v88, v70
    v_cvt_pk_bf16_f32 v90, v90, v71
    v_fma_mix_f32 v89, v68, v40, v44 op_sel:[0,0,0] op_sel_hi:[1,0,0]
    v_fma_mix_f32 v70, v69, v41, v44 op_sel:[0,0,0] op_sel_hi:[1,0,0]
    v_fma_mix_f32 v91, v68, v40, v44 op_sel:[1,0,0] op_sel_hi:[1,0,0]
    v_fma_mix_f32 v71, v69, v41, v44 op_sel:[1,0,0] op_sel_hi:[1,0,0]
    v_cvt_pk_bf16_f32 v89, v89, v70
    v_cvt_pk_bf16_f32 v91, v91, v71
    v_and_b32 v68, s34, v101
    v_and_b32 v69, s35, v101
    v_lshrrev_b32_e64 v101, 8, v101
    v_fma_mix_f32 v92, v68, v42, v45 op_sel:[0,0,0] op_sel_hi:[1,0,0]
    v_fma_mix_f32 v70, v69, v43, v45 op_sel:[0,0,0] op_sel_hi:[1,0,0]
    v_fma_mix_f32 v94, v68, v42, v45 op_sel:[1,0,0] op_sel_hi:[1,0,0]
    v_fma_mix_f32 v71, v69, v43, v45 op_sel:[1,0,0] op_sel_hi:[1,0,0]
    v_and_b32 v68, s34, v101
    v_and_b32 v69, s35, v101
    v_cvt_pk_bf16_f32 v92, v92, v70
    v_cvt_pk_bf16_f32 v94, v94, v71
    v_fma_mix_f32 v93, v68, v42, v45 op_sel:[0,0,0] op_sel_hi:[1,0,0]
    v_fma_mix_f32 v70, v69, v43, v45 op_sel:[0,0,0] op_sel_hi:[1,0,0]
    v_fma_mix_f32 v95, v68, v42, v45 op_sel:[1,0,0] op_sel_hi:[1,0,0]
    v_fma_mix_f32 v71, v69, v43, v45 op_sel:[1,0,0] op_sel_hi:[1,0,0]
    v_cvt_pk_bf16_f32 v93, v93, v70
    v_cvt_pk_bf16_f32 v95, v95, v71
    v_and_b32 v68, s34, v102
    v_and_b32 v69, s35, v102
    v_lshrrev_b32_e64 v102, 8, v102
    v_fma_mix_f32 v96, v68, v40, v44 op_sel:[0,0,0] op_sel_hi:[1,0,0]
    v_fma_mix_f32 v70, v69, v41, v44 op_sel:[0,0,0] op_sel_hi:[1,0,0]
    v_fma_mix_f32 v98, v68, v40, v44 op_sel:[1,0,0] op_sel_hi:[1,0,0]
    v_fma_mix_f32 v71, v69, v41, v44 op_sel:[1,0,0] op_sel_hi:[1,0,0]
    v_and_b32 v68, s34, v102
    v_and_b32 v69, s35, v102
    v_cvt_pk_bf16_f32 v96, v96, v70
    v_cvt_pk_bf16_f32 v98, v98, v71
    v_fma_mix_f32 v97, v68, v40, v44 op_sel:[0,0,0] op_sel_hi:[1,0,0]
    v_fma_mix_f32 v70, v69, v41, v44 op_sel:[0,0,0] op_sel_hi:[1,0,0]
    v_fma_mix_f32 v99, v68, v40, v44 op_sel:[1,0,0] op_sel_hi:[1,0,0]
    v_fma_mix_f32 v71, v69, v41, v44 op_sel:[1,0,0] op_sel_hi:[1,0,0]
    v_cvt_pk_bf16_f32 v97, v97, v70
    v_cvt_pk_bf16_f32 v99, v99, v71
    v_and_b32 v68, s34, v103
    v_and_b32 v69, s35, v103
    v_lshrrev_b32_e64 v103, 8, v103
    v_fma_mix_f32 v100, v68, v42, v45 op_sel:[0,0,0] op_sel_hi:[1,0,0]
    v_fma_mix_f32 v70, v69, v43, v45 op_sel:[0,0,0] op_sel_hi:[1,0,0]
    v_fma_mix_f32 v102, v68, v42, v45 op_sel:[1,0,0] op_sel_hi:[1,0,0]
    v_fma_mix_f32 v71, v69, v43, v45 op_sel:[1,0,0] op_sel_hi:[1,0,0]
    v_and_b32 v68, s34, v103
    v_and_b32 v69, s35, v103
    v_cvt_pk_bf16_f32 v100, v100, v70
    v_cvt_pk_bf16_f32 v102, v102, v71
    v_fma_mix_f32 v101, v68, v42, v45 op_sel:[0,0,0] op_sel_hi:[1,0,0]
    v_fma_mix_f32 v70, v69, v43, v45 op_sel:[0,0,0] op_sel_hi:[1,0,0]
    v_fma_mix_f32 v103, v68, v42, v45 op_sel:[1,0,0] op_sel_hi:[1,0,0]
    v_fma_mix_f32 v71, v69, v43, v45 op_sel:[1,0,0] op_sel_hi:[1,0,0]
    v_cvt_pk_bf16_f32 v101, v101, v70
    v_cvt_pk_bf16_f32 v103, v103, v71
    s_waitcnt vmcnt(0) lgkmcnt(0)
    v_and_b32 v68, s34, v84
    v_and_b32 v69, s35, v84
    v_lshrrev_b32 v84, 8, v84
    v_fma_mix_f32 v72, v68, v52, v66 op_sel:[0,0,0] op_sel_hi:[1,0,0]
    v_fma_mix_f32 v70, v69, v53, v66 op_sel:[0,0,0] op_sel_hi:[1,0,0]
    v_fma_mix_f32 v74, v68, v52, v66 op_sel:[1,0,0] op_sel_hi:[1,0,0]
    v_fma_mix_f32 v71, v69, v53, v66 op_sel:[1,0,0] op_sel_hi:[1,0,0]
    v_and_b32 v68, s34, v84
    v_and_b32 v69, s35, v84
    v_cvt_pk_bf16_f32 v72, v72, v70
    v_cvt_pk_bf16_f32 v74, v74, v71
    v_fma_mix_f32 v73, v68, v52, v66 op_sel:[0,0,0] op_sel_hi:[1,0,0]
    v_fma_mix_f32 v70, v69, v53, v66 op_sel:[0,0,0] op_sel_hi:[1,0,0]
    v_fma_mix_f32 v75, v68, v52, v66 op_sel:[1,0,0] op_sel_hi:[1,0,0]
    v_fma_mix_f32 v71, v69, v53, v66 op_sel:[1,0,0] op_sel_hi:[1,0,0]
    v_cvt_pk_bf16_f32 v73, v73, v70
    v_cvt_pk_bf16_f32 v75, v75, v71
    v_and_b32 v68, s34, v85
    v_and_b32 v69, s35, v85
    v_lshrrev_b32_e64 v85, 8, v85
    v_fma_mix_f32 v76, v68, v54, v67 op_sel:[0,0,0] op_sel_hi:[1,0,0]
    v_fma_mix_f32 v70, v69, v55, v67 op_sel:[0,0,0] op_sel_hi:[1,0,0]
    v_fma_mix_f32 v78, v68, v54, v67 op_sel:[1,0,0] op_sel_hi:[1,0,0]
    v_fma_mix_f32 v71, v69, v55, v67 op_sel:[1,0,0] op_sel_hi:[1,0,0]
    v_and_b32 v68, s34, v85
    v_and_b32 v69, s35, v85
    v_cvt_pk_bf16_f32 v76, v76, v70
    v_cvt_pk_bf16_f32 v78, v78, v71
    v_fma_mix_f32 v77, v68, v54, v67 op_sel:[0,0,0] op_sel_hi:[1,0,0]
    v_fma_mix_f32 v70, v69, v55, v67 op_sel:[0,0,0] op_sel_hi:[1,0,0]
    v_fma_mix_f32 v79, v68, v54, v67 op_sel:[1,0,0] op_sel_hi:[1,0,0]
    v_fma_mix_f32 v71, v69, v55, v67 op_sel:[1,0,0] op_sel_hi:[1,0,0]
    v_cvt_pk_bf16_f32 v77, v77, v70
    v_cvt_pk_bf16_f32 v79, v79, v71
    v_and_b32 v68, s34, v86
    v_and_b32 v69, s35, v86
    v_lshrrev_b32_e64 v86, 8, v86
    v_fma_mix_f32 v80, v68, v52, v66 op_sel:[0,0,0] op_sel_hi:[1,0,0]
    v_fma_mix_f32 v70, v69, v53, v66 op_sel:[0,0,0] op_sel_hi:[1,0,0]
    v_fma_mix_f32 v82, v68, v52, v66 op_sel:[1,0,0] op_sel_hi:[1,0,0]
    v_fma_mix_f32 v71, v69, v53, v66 op_sel:[1,0,0] op_sel_hi:[1,0,0]
    v_and_b32 v68, s34, v86
    v_and_b32 v69, s35, v86
    v_cvt_pk_bf16_f32 v80, v80, v70
    v_cvt_pk_bf16_f32 v82, v82, v71
    v_fma_mix_f32 v81, v68, v52, v66 op_sel:[0,0,0] op_sel_hi:[1,0,0]
    v_fma_mix_f32 v70, v69, v53, v66 op_sel:[0,0,0] op_sel_hi:[1,0,0]
    v_fma_mix_f32 v83, v68, v52, v66 op_sel:[1,0,0] op_sel_hi:[1,0,0]
    v_fma_mix_f32 v71, v69, v53, v66 op_sel:[1,0,0] op_sel_hi:[1,0,0]
    v_cvt_pk_bf16_f32 v81, v81, v70
    v_cvt_pk_bf16_f32 v83, v83, v71
    v_and_b32 v68, s34, v87
    v_and_b32 v69, s35, v87
    v_lshrrev_b32_e64 v87, 8, v87
    v_fma_mix_f32 v84, v68, v54, v67 op_sel:[0,0,0] op_sel_hi:[1,0,0]
    v_fma_mix_f32 v70, v69, v55, v67 op_sel:[0,0,0] op_sel_hi:[1,0,0]
    v_fma_mix_f32 v86, v68, v54, v67 op_sel:[1,0,0] op_sel_hi:[1,0,0]
    v_fma_mix_f32 v71, v69, v55, v67 op_sel:[1,0,0] op_sel_hi:[1,0,0]
    v_and_b32 v68, s34, v87
    v_and_b32 v69, s35, v87
    v_cvt_pk_bf16_f32 v84, v84, v70
    v_cvt_pk_bf16_f32 v86, v86, v71
    v_fma_mix_f32 v85, v68, v54, v67 op_sel:[0,0,0] op_sel_hi:[1,0,0]
    v_fma_mix_f32 v70, v69, v55, v67 op_sel:[0,0,0] op_sel_hi:[1,0,0]
    v_fma_mix_f32 v87, v68, v54, v67 op_sel:[1,0,0] op_sel_hi:[1,0,0]
    v_fma_mix_f32 v71, v69, v55, v67 op_sel:[1,0,0] op_sel_hi:[1,0,0]
    v_cvt_pk_bf16_f32 v85, v85, v70
    v_cvt_pk_bf16_f32 v87, v87, v71
    s_cmp_ge_u32 s27, 7
    s_cbranch_scc0 L_main14
    s_branch L_main15
L_h2:
    s_call_b64 s[50:51], L_issue
    s_call_b64 s[50:51], L_issue
    s_waitcnt vmcnt(16)
    s_barrier
    s_setprio 0
    s_call_b64 s[50:51], L_issue
    s_waitcnt vmcnt(16)
    s_barrier
    s_barrier
    s_call_b64 s[50:51], L_issue
    s_waitcnt vmcnt(16)
    s_barrier
    s_barrier
    s_call_b64 s[50:51], L_issue
    s_waitcnt vmcnt(16)
    s_barrier
    s_barrier
    s_call_b64 s[50:51], L_issue
    s_waitcnt vmcnt(16)
    s_barrier
    s_barrier
    s_call_b64 s[50:51], L_issue
    s_waitcnt vmcnt(16)
    s_barrier
    s_barrier
    s_call_b64 s[50:51], L_issue
    s_waitcnt vmcnt(16)
    s_barrier
    s_barrier
    s_call_b64 s[50:51], L_issue
    s_waitcnt vmcnt(16)
    s_barrier
    s_barrier
    s_call_b64 s[50:51], L_issue
    s_waitcnt vmcnt(16)
    s_barrier
    s_barrier
    s_call_b64 s[50:51], L_issue
    s_waitcnt vmcnt(16)
    s_barrier
    s_barrier
    s_call_b64 s[50:51], L_issue
    s_waitcnt vmcnt(16)
    s_barrier
    s_barrier
    s_call_b64 s[50:51], L_issue
    s_add_u32 s30, s41, 128
    s_and_b32 s30, s30, 2047
    s_add_u32 s30, s30, s40
    s_sub_u32 s31, s47, 100352
    s_mov_b32 m0, s31
    s_add_u32 s31, s31, 4096
    buffer_load_dwordx4 v10, s[4:7], s30 offen lds
    s_mov_b32 m0, s31
    s_add_u32 s30, s30, 65536
    s_add_u32 s31, s31, 4096
    buffer_load_dwordx4 v10, s[4:7], s30 offen lds
    s_mov_b32 m0, s31
    s_add_u32 s30, s30, 65536
    s_waitcnt vmcnt(18)
    s_barrier
    s_barrier
    s_call_b64 s[50:51], L_issue
    s_waitcnt vmcnt(18)
    s_barrier
    s_waitcnt vmcnt(6)
    s_barrier
    s_cmp_eq_u32 s45, 0
    s_cbranch_scc1 L_h15
    s_add_u32 m0, s31, 20480
    s_add_u32 s32, s30, 327680
    buffer_load_dwordx4 v10, s[4:7], s32 offen lds
L_h15:
    s_mov_b32 m0, s31
    s_nop 0
    buffer_load_dwordx4 v10, s[4:7], s30 offen lds
    s_add_u32 m0, m0, 4096
    s_add_u32 s30, s30, 65536
    buffer_load_dwordx4 v10, s[4:7], s30 offen lds
    s_add_u32 m0, m0, 4096
    s_add_u32 s30, s30, 65536
    buffer_load_dwordx4 v10, s[4:7], s30 offen lds
    s_add_u32 m0, m0, 4096
    s_add_u32 s30, s30, 65536
    buffer_load_dwordx4 v10, s[4:7], s30 offen lds
    s_add_u32 m0, m0, 4096
    s_add_u32 s30, s30, 65536
    buffer_load_dwordx4 v10, s[4:7], s30 offen lds
    s_waitcnt vmcnt(3)
    s_barrier
    s_waitcnt vmcnt(0)
    s_barrier
L_end:
    s_endpgm
.p2align 6
L_main14:
    s_mov_b64 vcc, 0
    s_barrier
    ds_read_b128 v[8:11], v2 offset:30720
    ds_read_b128 v[12:15], v2 offset:32768
    ds_read_b128 v[16:19], v2 offset:34816
    ds_read_b128 v[20:23], v2 offset:36864
    ds_read_b128 v[24:27], v2 offset:38912
    ds_read_b128 v[28:31], v2 offset:40960
    ds_read_b128 v[32:35], v2 offset:43008
    ds_read_b128 v[36:39], v2 offset:45056
    s_waitcnt lgkmcnt(4)
.p2alignl 6, 0xbf800000
L_loop14:
    v_mfma_f32_16x16x32_bf16 v[136:139], v[8:11], v[120:123], v[136:139]
    v_and_b32_e64 v68, s34, v58
    v_and_b32_e64 v69, s35, v58
    v_mfma_f32_16x16x32_bf16 v[140:143], v[8:11], v[124:127], v[140:143]
    ds_read_b128 v[8:11], v2 offset:47104
    v_lshrrev_b32_e64 v58, 8, v58
    v_mfma_f32_16x16x32_bf16 v[144:147], v[12:15], v[120:123], v[144:147]
    ds_read2st64_b64 v[48:51], v4 offset0:8 offset1:12
    v_fma_mix_f32 v128, v68, v60, v64 op_sel:[0,0,0] op_sel_hi:[1,0,0]
    v_mfma_f32_16x16x32_bf16 v[148:151], v[12:15], v[124:127], v[148:151]
    ds_read_b128 v[12:15], v2 offset:49152
    v_fma_mix_f32 v70, v69, v61, v64 op_sel:[0,0,0] op_sel_hi:[1,0,0]
    v_mfma_f32_16x16x32_bf16 v[152:155], v[16:19], v[120:123], v[152:155]
    v_xor_b32 v4, 0x2000, v4
    v_fma_mix_f32 v130, v68, v60, v64 op_sel:[1,0,0] op_sel_hi:[1,0,0]
    v_mfma_f32_16x16x32_bf16 v[156:159], v[16:19], v[124:127], v[156:159]
    ds_read_b128 v[16:19], v2 offset:51200
    v_fma_mix_f32 v71, v69, v61, v64 op_sel:[1,0,0] op_sel_hi:[1,0,0]
    v_mfma_f32_16x16x32_bf16 v[160:163], v[20:23], v[120:123], v[160:163]
    ds_read_b128 v[52:55], v5 offset:1536
    v_and_b32 v68, s34, v58
    v_mfma_f32_16x16x32_bf16 v[164:167], v[20:23], v[124:127], v[164:167]
    ds_read_b128 v[20:23], v2 offset:53248
    s_waitcnt lgkmcnt(6)
    v_mfma_f32_16x16x32_bf16 v[168:171], v[24:27], v[120:123], v[168:171]
    ds_read_b64 v[66:67], v6 offset:1536
    v_and_b32_e64 v69, s35, v58
    v_mfma_f32_16x16x32_bf16 v[172:175], v[24:27], v[124:127], v[172:175]
    ds_read_b128 v[24:27], v2 offset:55296
    v_cvt_pk_bf16_f32 v128, v128, v70
    v_mfma_f32_16x16x32_bf16 v[176:179], v[28:31], v[120:123], v[176:179]
    v_cvt_pk_bf16_f32 v130, v130, v71
    v_fma_mix_f32 v129, v68, v60, v64 op_sel:[0,0,0] op_sel_hi:[1,0,0]
    v_mfma_f32_16x16x32_bf16 v[180:183], v[28:31], v[124:127], v[180:183]
    ds_read_b128 v[28:31], v2 offset:57344
    v_fma_mix_f32 v70, v69, v61, v64 op_sel:[0,0,0] op_sel_hi:[1,0,0]
    v_mfma_f32_16x16x32_bf16 v[184:187], v[32:35], v[120:123], v[184:187]
    v_fma_mix_f32 v131, v68, v60, v64 op_sel:[1,0,0] op_sel_hi:[1,0,0]
    v_fma_mix_f32 v71, v69, v61, v64 op_sel:[1,0,0] op_sel_hi:[1,0,0]
    v_mfma_f32_16x16x32_bf16 v[188:191], v[32:35], v[124:127], v[188:191]
    ds_read_b128 v[32:35], v3 offset:30720
    v_cvt_pk_bf16_f32 v129, v129, v70
    v_mfma_f32_16x16x32_bf16 v[192:195], v[36:39], v[120:123], v[192:195]
    v_cvt_pk_bf16_f32 v131, v131, v71
    v_and_b32_e64 v68, s34, v59
    v_mfma_f32_16x16x32_bf16 v[196:199], v[36:39], v[124:127], v[196:199]
    ds_read_b128 v[36:39], v3 offset:32768
    s_waitcnt lgkmcnt(5)
    v_mfma_f32_16x16x32_bf16 v[200:203], v[8:11], v[120:123], v[200:203]
    v_and_b32 v69, s35, v59
    v_lshrrev_b32_e64 v59, 8, v59
    v_mfma_f32_16x16x32_bf16 v[204:207], v[8:11], v[124:127], v[204:207]
    ds_read_b128 v[8:11], v3 offset:34816
    v_fma_mix_f32 v132, v68, v62, v65 op_sel:[0,0,0] op_sel_hi:[1,0,0]
    v_mfma_f32_16x16x32_bf16 v[208:211], v[12:15], v[120:123], v[208:211]
    v_fma_mix_f32 v70, v69, v63, v65 op_sel:[0,0,0] op_sel_hi:[1,0,0]
    v_fma_mix_f32 v134, v68, v62, v65 op_sel:[1,0,0] op_sel_hi:[1,0,0]
    v_mfma_f32_16x16x32_bf16 v[212:215], v[12:15], v[124:127], v[212:215]
    ds_read_b128 v[12:15], v3 offset:36864
    v_fma_mix_f32 v71, v69, v63, v65 op_sel:[1,0,0] op_sel_hi:[1,0,0]
    v_mfma_f32_16x16x32_bf16 v[216:219], v[16:19], v[120:123], v[216:219]
    v_and_b32_e64 v68, s34, v59
    v_and_b32 v69, s35, v59
    v_mfma_f32_16x16x32_bf16 v[220:223], v[16:19], v[124:127], v[220:223]
    ds_read_b128 v[16:19], v3 offset:38912
    v_cvt_pk_bf16_f32 v132, v132, v70
    v_mfma_f32_16x16x32_bf16 v[224:227], v[20:23], v[120:123], v[224:227]
    v_cvt_pk_bf16_f32 v134, v134, v71
    v_fma_mix_f32 v133, v68, v62, v65 op_sel:[0,0,0] op_sel_hi:[1,0,0]
    v_mfma_f32_16x16x32_bf16 v[228:231], v[20:23], v[124:127], v[228:231]
    ds_read_b128 v[20:23], v3 offset:40960
    s_waitcnt lgkmcnt(4)
    v_mfma_f32_16x16x32_bf16 v[232:235], v[24:27], v[120:123], v[232:235]
    v_fma_mix_f32 v70, v69, v63, v65 op_sel:[0,0,0] op_sel_hi:[1,0,0]
    v_fma_mix_f32 v135, v68, v62, v65 op_sel:[1,0,0] op_sel_hi:[1,0,0]
    v_mfma_f32_16x16x32_bf16 v[236:239], v[24:27], v[124:127], v[236:239]
    ds_read_b128 v[24:27], v3 offset:43008
    v_fma_mix_f32 v71, v69, v63, v65 op_sel:[1,0,0] op_sel_hi:[1,0,0]
    v_mfma_f32_16x16x32_bf16 v[240:243], v[28:31], v[120:123], v[240:243]
    v_cvt_pk_bf16_f32 v133, v133, v70
    v_cvt_pk_bf16_f32 v135, v135, v71
    v_mfma_f32_16x16x32_bf16 v[244:247], v[28:31], v[124:127], v[244:247]
    ds_read_b128 v[28:31], v3 offset:45056
    v_mfma_f32_16x16x32_bf16 v[136:139], v[32:35], v[128:131], v[136:139]
    v_and_b32_e64 v68, s34, v48
    v_and_b32_e64 v69, s35, v48
    v_mfma_f32_16x16x32_bf16 v[140:143], v[32:35], v[132:135], v[140:143]
    ds_read_b128 v[32:35], v3 offset:47104
    v_lshrrev_b32 v48, 8, v48
    v_mfma_f32_16x16x32_bf16 v[144:147], v[36:39], v[128:131], v[144:147]
    v_fma_mix_f32 v120, v68, v52, v66 op_sel:[0,0,0] op_sel_hi:[1,0,0]
    v_fma_mix_f32 v70, v69, v53, v66 op_sel:[0,0,0] op_sel_hi:[1,0,0]
    v_mfma_f32_16x16x32_bf16 v[148:151], v[36:39], v[132:135], v[148:151]
    ds_read_b128 v[36:39], v3 offset:49152
    s_waitcnt lgkmcnt(4)
    v_mfma_f32_16x16x32_bf16 v[152:155], v[8:11], v[128:131], v[152:155]
    v_fma_mix_f32 v122, v68, v52, v66 op_sel:[1,0,0] op_sel_hi:[1,0,0]
    v_fma_mix_f32 v71, v69, v53, v66 op_sel:[1,0,0] op_sel_hi:[1,0,0]
    v_mfma_f32_16x16x32_bf16 v[156:159], v[8:11], v[132:135], v[156:159]
    ds_read_b128 v[8:11], v3 offset:51200
    v_and_b32_e64 v68, s34, v48
    v_mfma_f32_16x16x32_bf16 v[160:163], v[12:15], v[128:131], v[160:163]
    v_and_b32_e64 v69, s35, v48
    v_cvt_pk_bf16_f32 v120, v120, v70
    v_mfma_f32_16x16x32_bf16 v[164:167], v[12:15], v[132:135], v[164:167]
    ds_read_b128 v[12:15], v3 offset:53248
    v_cvt_pk_bf16_f32 v122, v122, v71
    v_mfma_f32_16x16x32_bf16 v[168:171], v[16:19], v[128:131], v[168:171]
    v_fma_mix_f32 v121, v68, v52, v66 op_sel:[0,0,0] op_sel_hi:[1,0,0]
    v_fma_mix_f32 v70, v69, v53, v66 op_sel:[0,0,0] op_sel_hi:[1,0,0]
    v_mfma_f32_16x16x32_bf16 v[172:175], v[16:19], v[132:135], v[172:175]
    ds_read_b128 v[16:19], v3 offset:55296
    v_fma_mix_f32 v123, v68, v52, v66 op_sel:[1,0,0] op_sel_hi:[1,0,0]
    v_mfma_f32_16x16x32_bf16 v[176:179], v[20:23], v[128:131], v[176:179]
    v_fma_mix_f32 v71, v69, v53, v66 op_sel:[1,0,0] op_sel_hi:[1,0,0]
    v_cvt_pk_bf16_f32 v121, v121, v70
    v_mfma_f32_16x16x32_bf16 v[180:183], v[20:23], v[132:135], v[180:183]
    ds_read_b128 v[20:23], v3 offset:57344
    s_waitcnt lgkmcnt(4)
    v_mfma_f32_16x16x32_bf16 v[184:187], v[24:27], v[128:131], v[184:187]
    s_barrier
    v_cvt_pk_bf16_f32 v123, v123, v71
    v_mfma_f32_16x16x32_bf16 v[188:191], v[24:27], v[132:135], v[188:191]
    ds_read_b128 v[24:27], v2 offset:0
    v_mfma_f32_16x16x32_bf16 v[192:195], v[28:31], v[128:131], v[192:195]
    v_and_b32_e64 v68, s34, v49
    v_and_b32_e64 v69, s35, v49
    v_mfma_f32_16x16x32_bf16 v[196:199], v[28:31], v[132:135], v[196:199]
    ds_read_b128 v[28:31], v2 offset:2048
    v_lshrrev_b32_e64 v49, 8, v49
    v_mfma_f32_16x16x32_bf16 v[200:203], v[32:35], v[128:131], v[200:203]
    v_fma_mix_f32 v124, v68, v54, v67 op_sel:[0,0,0] op_sel_hi:[1,0,0]
    v_fma_mix_f32 v70, v69, v55, v67 op_sel:[0,0,0] op_sel_hi:[1,0,0]
    v_mfma_f32_16x16x32_bf16 v[204:207], v[32:35], v[132:135], v[204:207]
    ds_read_b128 v[32:35], v2 offset:4096
    v_fma_mix_f32 v126, v68, v54, v67 op_sel:[1,0,0] op_sel_hi:[1,0,0]
    v_mfma_f32_16x16x32_bf16 v[208:211], v[36:39], v[128:131], v[208:211]
    v_fma_mix_f32 v71, v69, v55, v67 op_sel:[1,0,0] op_sel_hi:[1,0,0]
    v_and_b32_e64 v68, s34, v49
    v_mfma_f32_16x16x32_bf16 v[212:215], v[36:39], v[132:135], v[212:215]
    ds_read_b128 v[36:39], v2 offset:6144
    s_waitcnt lgkmcnt(4)
    v_mfma_f32_16x16x32_bf16 v[216:219], v[8:11], v[128:131], v[216:219]
    s_barrier
    v_and_b32_e64 v69, s35, v49
    v_mfma_f32_16x16x32_bf16 v[220:223], v[8:11], v[132:135], v[220:223]
    ds_read_b128 v[8:11], v2 offset:8192
    v_cvt_pk_bf16_f32 v124, v124, v70
    v_mfma_f32_16x16x32_bf16 v[224:227], v[12:15], v[128:131], v[224:227]
    v_cvt_pk_bf16_f32 v126, v126, v71
    v_fma_mix_f32 v125, v68, v54, v67 op_sel:[0,0,0] op_sel_hi:[1,0,0]
    v_mfma_f32_16x16x32_bf16 v[228:231], v[12:15], v[132:135], v[228:231]
    ds_read_b128 v[12:15], v2 offset:10240
    v_fma_mix_f32 v70, v69, v55, v67 op_sel:[0,0,0] op_sel_hi:[1,0,0]
    v_mfma_f32_16x16x32_bf16 v[232:235], v[16:19], v[128:131], v[232:235]
    v_fma_mix_f32 v127, v68, v54, v67 op_sel:[1,0,0] op_sel_hi:[1,0,0]
    v_fma_mix_f32 v71, v69, v55, v67 op_sel:[1,0,0] op_sel_hi:[1,0,0]
    v_mfma_f32_16x16x32_bf16 v[236:239], v[16:19], v[132:135], v[236:239]
    ds_read_b128 v[16:19], v2 offset:12288
    v_cvt_pk_bf16_f32 v125, v125, v70
    v_mfma_f32_16x16x32_bf16 v[240:243], v[20:23], v[128:131], v[240:243]
    v_cvt_pk_bf16_f32 v127, v127, v71
    v_mfma_f32_16x16x32_bf16 v[244:247], v[20:23], v[132:135], v[244:247]
    ds_read_b128 v[20:23], v2 offset:14336
    s_waitcnt lgkmcnt(4)
    v_mfma_f32_16x16x32_bf16 v[136:139], v[24:27], v[120:123], v[136:139]
    v_and_b32 v68, s34, v50
    v_and_b32 v69, s35, v50
    v_mfma_f32_16x16x32_bf16 v[140:143], v[24:27], v[124:127], v[140:143]
    ds_read_b128 v[24:27], v2 offset:16384
    v_lshrrev_b32 v50, 8, v50
    v_mfma_f32_16x16x32_bf16 v[144:147], v[28:31], v[120:123], v[144:147]
    ds_read2st64_b64 v[56:59], v4 offset0:0 offset1:4
    v_fma_mix_f32 v128, v68, v52, v66 op_sel:[0,0,0] op_sel_hi:[1,0,0]
    v_mfma_f32_16x16x32_bf16 v[148:151], v[28:31], v[124:127], v[148:151]
    ds_read_b128 v[28:31], v2 offset:18432
    v_fma_mix_f32 v70, v69, v53, v66 op_sel:[0,0,0] op_sel_hi:[1,0,0]
    v_mfma_f32_16x16x32_bf16 v[152:155], v[32:35], v[120:123], v[152:155]
    ds_read_b128 v[60:63], v5 offset:0
    v_fma_mix_f32 v130, v68, v52, v66 op_sel:[1,0,0] op_sel_hi:[1,0,0]
    v_mfma_f32_16x16x32_bf16 v[156:159], v[32:35], v[124:127], v[156:159]
    ds_read_b128 v[32:35], v2 offset:20480
    v_fma_mix_f32 v71, v69, v53, v66 op_sel:[1,0,0] op_sel_hi:[1,0,0]
    v_mfma_f32_16x16x32_bf16 v[160:163], v[36:39], v[120:123], v[160:163]
    v_subrev_u32 v5, 3072, v5
    v_and_b32 v68, s34, v50
    v_mfma_f32_16x16x32_bf16 v[164:167], v[36:39], v[124:127], v[164:167]
    ds_read_b128 v[36:39], v2 offset:22528
    s_waitcnt lgkmcnt(6)
    v_mfma_f32_16x16x32_bf16 v[168:171], v[8:11], v[120:123], v[168:171]
    ds_read_b64 v[64:65], v6 offset:0
    v_and_b32_e64 v69, s35, v50
    v_mfma_f32_16x16x32_bf16 v[172:175], v[8:11], v[124:127], v[172:175]
    ds_read_b128 v[8:11], v2 offset:24576
    v_cvt_pk_bf16_f32 v128, v128, v70
    v_mfma_f32_16x16x32_bf16 v[176:179], v[12:15], v[120:123], v[176:179]
    v_subrev_u32 v6, 3072, v6
    v_cvt_pk_bf16_f32 v130, v130, v71
    v_mfma_f32_16x16x32_bf16 v[180:183], v[12:15], v[124:127], v[180:183]
    ds_read_b128 v[12:15], v2 offset:26624
    v_fma_mix_f32 v129, v68, v52, v66 op_sel:[0,0,0] op_sel_hi:[1,0,0]
    v_mfma_f32_16x16x32_bf16 v[184:187], v[16:19], v[120:123], v[184:187]
    v_add_u32_e64 v2, s37, v2
    v_fma_mix_f32 v70, v69, v53, v66 op_sel:[0,0,0] op_sel_hi:[1,0,0]
    v_mfma_f32_16x16x32_bf16 v[188:191], v[16:19], v[124:127], v[188:191]
    ds_read_b128 v[16:19], v3 offset:0
    v_fma_mix_f32 v131, v68, v52, v66 op_sel:[1,0,0] op_sel_hi:[1,0,0]
    v_mfma_f32_16x16x32_bf16 v[192:195], v[20:23], v[120:123], v[192:195]
    v_fma_mix_f32 v71, v69, v53, v66 op_sel:[1,0,0] op_sel_hi:[1,0,0]
    v_cvt_pk_bf16_f32 v129, v129, v70
    v_mfma_f32_16x16x32_bf16 v[196:199], v[20:23], v[124:127], v[196:199]
    ds_read_b128 v[20:23], v3 offset:2048
    v_cvt_pk_bf16_f32 v131, v131, v71
    s_waitcnt lgkmcnt(5)
    v_mfma_f32_16x16x32_bf16 v[200:203], v[24:27], v[120:123], v[200:203]
    v_and_b32 v68, s34, v51
    v_and_b32_e64 v69, s35, v51
    v_mfma_f32_16x16x32_bf16 v[204:207], v[24:27], v[124:127], v[204:207]
    ds_read_b128 v[24:27], v3 offset:4096
    v_lshrrev_b32_e64 v51, 8, v51
    v_mfma_f32_16x16x32_bf16 v[208:211], v[28:31], v[120:123], v[208:211]
    v_fma_mix_f32 v132, v68, v54, v67 op_sel:[0,0,0] op_sel_hi:[1,0,0]
    v_fma_mix_f32 v70, v69, v55, v67 op_sel:[0,0,0] op_sel_hi:[1,0,0]
    v_mfma_f32_16x16x32_bf16 v[212:215], v[28:31], v[124:127], v[212:215]
    ds_read_b128 v[28:31], v3 offset:6144
    v_fma_mix_f32 v134, v68, v54, v67 op_sel:[1,0,0] op_sel_hi:[1,0,0]
    v_mfma_f32_16x16x32_bf16 v[216:219], v[32:35], v[120:123], v[216:219]
    v_fma_mix_f32 v71, v69, v55, v67 op_sel:[1,0,0] op_sel_hi:[1,0,0]
    v_and_b32_e64 v68, s34, v51
    v_mfma_f32_16x16x32_bf16 v[220:223], v[32:35], v[124:127], v[220:223]
    ds_read_b128 v[32:35], v3 offset:8192
    v_and_b32 v69, s35, v51
    v_mfma_f32_16x16x32_bf16 v[224:227], v[36:39], v[120:123], v[224:227]
    v_cvt_pk_bf16_f32 v132, v132, v70
    v_cvt_pk_bf16_f32 v134, v134, v71
    v_mfma_f32_16x16x32_bf16 v[228:231], v[36:39], v[124:127], v[228:231]
    ds_read_b128 v[36:39], v3 offset:10240
    s_waitcnt lgkmcnt(4)
    v_mfma_f32_16x16x32_bf16 v[232:235], v[8:11], v[120:123], v[232:235]
    v_fma_mix_f32 v133, v68, v54, v67 op_sel:[0,0,0] op_sel_hi:[1,0,0]
    v_fma_mix_f32 v70, v69, v55, v67 op_sel:[0,0,0] op_sel_hi:[1,0,0]
    v_mfma_f32_16x16x32_bf16 v[236:239], v[8:11], v[124:127], v[236:239]
    ds_read_b128 v[8:11], v3 offset:12288
    v_fma_mix_f32 v135, v68, v54, v67 op_sel:[1,0,0] op_sel_hi:[1,0,0]
    v_mfma_f32_16x16x32_bf16 v[240:243], v[12:15], v[120:123], v[240:243]
    v_fma_mix_f32 v71, v69, v55, v67 op_sel:[1,0,0] op_sel_hi:[1,0,0]
    v_cvt_pk_bf16_f32 v133, v133, v70
    v_mfma_f32_16x16x32_bf16 v[244:247], v[12:15], v[124:127], v[244:247]
    ds_read_b128 v[12:15], v3 offset:14336
    v_cvt_pk_bf16_f32 v135, v135, v71
    v_mfma_f32_16x16x32_bf16 v[136:139], v[16:19], v[128:131], v[136:139]
    v_and_b32 v68, s34, v56
    v_and_b32 v69, s35, v56
    v_mfma_f32_16x16x32_bf16 v[140:143], v[16:19], v[132:135], v[140:143]
    ds_read_b128 v[16:19], v3 offset:16384
    v_lshrrev_b32_e64 v56, 8, v56
    v_mfma_f32_16x16x32_bf16 v[144:147], v[20:23], v[128:131], v[144:147]
    v_fma_mix_f32 v120, v68, v60, v64 op_sel:[0,0,0] op_sel_hi:[1,0,0]
    v_fma_mix_f32 v70, v69, v61, v64 op_sel:[0,0,0] op_sel_hi:[1,0,0]
    v_mfma_f32_16x16x32_bf16 v[148:151], v[20:23], v[132:135], v[148:151]
    ds_read_b128 v[20:23], v3 offset:18432
    s_waitcnt lgkmcnt(4)
    v_mfma_f32_16x16x32_bf16 v[152:155], v[24:27], v[128:131], v[152:155]
    v_fma_mix_f32 v122, v68, v60, v64 op_sel:[1,0,0] op_sel_hi:[1,0,0]
    v_fma_mix_f32 v71, v69, v61, v64 op_sel:[1,0,0] op_sel_hi:[1,0,0]
    v_mfma_f32_16x16x32_bf16 v[156:159], v[24:27], v[132:135], v[156:159]
    ds_read_b128 v[24:27], v3 offset:20480
    v_and_b32 v68, s34, v56
    v_mfma_f32_16x16x32_bf16 v[160:163], v[28:31], v[128:131], v[160:163]
    v_and_b32_e64 v69, s35, v56
    v_cvt_pk_bf16_f32 v120, v120, v70
    v_mfma_f32_16x16x32_bf16 v[164:167], v[28:31], v[132:135], v[164:167]
    ds_read_b128 v[28:31], v3 offset:22528
    v_cvt_pk_bf16_f32 v122, v122, v71
    v_mfma_f32_16x16x32_bf16 v[168:171], v[32:35], v[128:131], v[168:171]
    v_fma_mix_f32 v121, v68, v60, v64 op_sel:[0,0,0] op_sel_hi:[1,0,0]
    v_fma_mix_f32 v70, v69, v61, v64 op_sel:[0,0,0] op_sel_hi:[1,0,0]
    v_mfma_f32_16x16x32_bf16 v[172:175], v[32:35], v[132:135], v[172:175]
    ds_read_b128 v[32:35], v3 offset:24576
    v_fma_mix_f32 v123, v68, v60, v64 op_sel:[1,0,0] op_sel_hi:[1,0,0]
    v_mfma_f32_16x16x32_bf16 v[176:179], v[36:39], v[128:131], v[176:179]
    v_fma_mix_f32 v71, v69, v61, v64 op_sel:[1,0,0] op_sel_hi:[1,0,0]
    v_cvt_pk_bf16_f32 v121, v121, v70
    v_mfma_f32_16x16x32_bf16 v[180:183], v[36:39], v[132:135], v[180:183]
    ds_read_b128 v[36:39], v3 offset:26624
    v_cvt_pk_bf16_f32 v123, v123, v71
    s_waitcnt lgkmcnt(4)
    v_mfma_f32_16x16x32_bf16 v[184:187], v[8:11], v[128:131], v[184:187]
    s_barrier
    v_and_b32_e64 v68, s34, v57
    v_mfma_f32_16x16x32_bf16 v[188:191], v[8:11], v[132:135], v[188:191]
    ds_read_b128 v[8:11], v2 offset:30720
    v_and_b32 v69, s35, v57
    v_mfma_f32_16x16x32_bf16 v[192:195], v[12:15], v[128:131], v[192:195]
    v_add_u32 v3, s37, v3
    v_lshrrev_b32_e64 v57, 8, v57
    v_mfma_f32_16x16x32_bf16 v[196:199], v[12:15], v[132:135], v[196:199]
    ds_read_b128 v[12:15], v2 offset:32768
    v_fma_mix_f32 v124, v68, v62, v65 op_sel:[0,0,0] op_sel_hi:[1,0,0]
    v_mfma_f32_16x16x32_bf16 v[200:203], v[16:19], v[128:131], v[200:203]
    s_sub_u32 s37, 0, s37
    v_fma_mix_f32 v70, v69, v63, v65 op_sel:[0,0,0] op_sel_hi:[1,0,0]
    v_mfma_f32_16x16x32_bf16 v[204:207], v[16:19], v[132:135], v[204:207]
    ds_read_b128 v[16:19], v2 offset:34816
    v_fma_mix_f32 v126, v68, v62, v65 op_sel:[1,0,0] op_sel_hi:[1,0,0]
    v_mfma_f32_16x16x32_bf16 v[208:211], v[20:23], v[128:131], v[208:211]
    s_sub_u32 s36, s36, 1
    v_fma_mix_f32 v71, v69, v63, v65 op_sel:[1,0,0] op_sel_hi:[1,0,0]
    v_mfma_f32_16x16x32_bf16 v[212:215], v[20:23], v[132:135], v[212:215]
    ds_read_b128 v[20:23], v2 offset:36864
    s_waitcnt lgkmcnt(4)
    v_mfma_f32_16x16x32_bf16 v[216:219], v[24:27], v[128:131], v[216:219]
    s_barrier
    v_and_b32 v68, s34, v57
    v_mfma_f32_16x16x32_bf16 v[220:223], v[24:27], v[132:135], v[220:223]
    ds_read_b128 v[24:27], v2 offset:38912
    v_and_b32 v69, s35, v57
    v_mfma_f32_16x16x32_bf16 v[224:227], v[28:31], v[128:131], v[224:227]
    v_cvt_pk_bf16_f32 v124, v124, v70
    v_cvt_pk_bf16_f32 v126, v126, v71
    v_mfma_f32_16x16x32_bf16 v[228:231], v[28:31], v[132:135], v[228:231]
    ds_read_b128 v[28:31], v2 offset:40960
    v_fma_mix_f32 v125, v68, v62, v65 op_sel:[0,0,0] op_sel_hi:[1,0,0]
    v_mfma_f32_16x16x32_bf16 v[232:235], v[32:35], v[128:131], v[232:235]
    v_fma_mix_f32 v70, v69, v63, v65 op_sel:[0,0,0] op_sel_hi:[1,0,0]
    v_fma_mix_f32 v127, v68, v62, v65 op_sel:[1,0,0] op_sel_hi:[1,0,0]
    v_mfma_f32_16x16x32_bf16 v[236:239], v[32:35], v[132:135], v[236:239]
    ds_read_b128 v[32:35], v2 offset:43008
    v_fma_mix_f32 v71, v69, v63, v65 op_sel:[1,0,0] op_sel_hi:[1,0,0]
    v_mfma_f32_16x16x32_bf16 v[240:243], v[36:39], v[128:131], v[240:243]
    v_cvt_pk_bf16_f32 v125, v125, v70
    v_cvt_pk_bf16_f32 v127, v127, v71
    v_mfma_f32_16x16x32_bf16 v[244:247], v[36:39], v[132:135], v[244:247]
    ds_read_b128 v[36:39], v2 offset:45056
    s_waitcnt lgkmcnt(4)
    s_cbranch_scc0 L_loop14
    s_branch L_tail
.p2align 6
L_main15:
    s_mov_b64 vcc, 1
    s_barrier
    ds_read_b128 v[8:11], v2 offset:30720
    ds_read_b128 v[12:15], v2 offset:32768
    ds_read_b128 v[16:19], v2 offset:34816
    ds_read_b128 v[20:23], v2 offset:36864
    ds_read_b128 v[24:27], v2 offset:38912
    ds_read_b128 v[28:31], v2 offset:40960
    ds_read_b128 v[32:35], v2 offset:43008
    ds_read_b128 v[36:39], v2 offset:45056
    ds_read_b128 v[40:43], v2 offset:47104
    ds_read_b128 v[44:47], v2 offset:49152
    s_waitcnt lgkmcnt(7)
.p2alignl 6, 0xbf800000
L_loop15:
    v_mfma_f32_16x16x32_bf16 v[136:139], v[8:11], v[120:123], v[136:139]
    v_and_b32_e64 v68, s34, v58
    v_and_b32_e64 v69, s35, v58
    v_mfma_f32_16x16x32_bf16 v[140:143], v[8:11], v[124:127], v[140:143]
    ds_read_b128 v[8:11], v2 offset:51200
    v_lshrrev_b32_e64 v58, 8, v58
    v_mfma_f32_16x16x32_bf16 v[144:147], v[12:15], v[120:123], v[144:147]
    ds_read2st64_b64 v[48:51], v4 offset0:8 offset1:12
    v_fma_mix_f32 v128, v68, v60, v64 op_sel:[0,0,0] op_sel_hi:[1,0,0]
    v_mfma_f32_16x16x32_bf16 v[148:151], v[12:15], v[124:127], v[148:151]
    ds_read_b128 v[12:15], v2 offset:53248
    v_fma_mix_f32 v70, v69, v61, v64 op_sel:[0,0,0] op_sel_hi:[1,0,0]
    v_mfma_f32_16x16x32_bf16 v[152:155], v[16:19], v[120:123], v[152:155]
    v_xor_b32 v4, 0x2000, v4
    v_fma_mix_f32 v130, v68, v60, v64 op_sel:[1,0,0] op_sel_hi:[1,0,0]
    v_mfma_f32_16x16x32_bf16 v[156:159], v[16:19], v[124:127], v[156:159]
    ds_read_b128 v[16:19], v2 offset:55296
    s_waitcnt lgkmcnt(8)
    v_mfma_f32_16x16x32_bf16 v[160:163], v[20:23], v[120:123], v[160:163]
    ds_read_b128 v[52:55], v5 offset:1536
    v_fma_mix_f32 v71, v69, v61, v64 op_sel:[1,0,0] op_sel_hi:[1,0,0]
    v_mfma_f32_16x16x32_bf16 v[164:167], v[20:23], v[124:127], v[164:167]
    ds_read_b128 v[20:23], v2 offset:57344
    v_and_b32_e64 v68, s34, v58
    v_mfma_f32_16x16x32_bf16 v[168:171], v[24:27], v[120:123], v[168:171]
    ds_read_b64 v[66:67], v6 offset:1536
    v_and_b32_e64 v69, s35, v58
    v_mfma_f32_16x16x32_bf16 v[172:175], v[24:27], v[124:127], v[172:175]
    ds_read_b128 v[24:27], v2 offset:59392
    v_cvt_pk_bf16_f32 v128, v128, v70
    v_mfma_f32_16x16x32_bf16 v[176:179], v[28:31], v[120:123], v[176:179]
    v_cvt_pk_bf16_f32 v130, v130, v71
    v_fma_mix_f32 v129, v68, v60, v64 op_sel:[0,0,0] op_sel_hi:[1,0,0]
    v_mfma_f32_16x16x32_bf16 v[180:183], v[28:31], v[124:127], v[180:183]
    ds_read_b128 v[28:31], v3 offset:30720
    s_waitcnt lgkmcnt(10)
    v_mfma_f32_16x16x32_bf16 v[184:187], v[32:35], v[120:123], v[184:187]
    v_fma_mix_f32 v70, v69, v61, v64 op_sel:[0,0,0] op_sel_hi:[1,0,0]
    v_fma_mix_f32 v131, v68, v60, v64 op_sel:[1,0,0] op_sel_hi:[1,0,0]
    v_mfma_f32_16x16x32_bf16 v[188:191], v[32:35], v[124:127], v[188:191]
    ds_read_b128 v[32:35], v3 offset:32768
    v_fma_mix_f32 v71, v69, v61, v64 op_sel:[1,0,0] op_sel_hi:[1,0,0]
    v_mfma_f32_16x16x32_bf16 v[192:195], v[36:39], v[120:123], v[192:195]
    v_cvt_pk_bf16_f32 v129, v129, v70
    v_mfma_f32_16x16x32_bf16 v[196:199], v[36:39], v[124:127], v[196:199]
    ds_read_b128 v[36:39], v3 offset:34816
    v_cvt_pk_bf16_f32 v131, v131, v71
    v_mfma_f32_16x16x32_bf16 v[200:203], v[40:43], v[120:123], v[200:203]
    v_and_b32_e64 v68, s34, v59
    v_and_b32 v69, s35, v59
    v_mfma_f32_16x16x32_bf16 v[204:207], v[40:43], v[124:127], v[204:207]
    ds_read_b128 v[40:43], v3 offset:36864
    s_waitcnt lgkmcnt(9)
    v_mfma_f32_16x16x32_bf16 v[208:211], v[44:47], v[120:123], v[208:211]
    v_lshrrev_b32_e64 v59, 8, v59
    v_fma_mix_f32 v132, v68, v62, v65 op_sel:[0,0,0] op_sel_hi:[1,0,0]
    v_mfma_f32_16x16x32_bf16 v[212:215], v[44:47], v[124:127], v[212:215]
    ds_read_b128 v[44:47], v3 offset:38912
    v_fma_mix_f32 v70, v69, v63, v65 op_sel:[0,0,0] op_sel_hi:[1,0,0]
    v_mfma_f32_16x16x32_bf16 v[216:219], v[8:11], v[120:123], v[216:219]
    v_fma_mix_f32 v134, v68, v62, v65 op_sel:[1,0,0] op_sel_hi:[1,0,0]
    v_fma_mix_f32 v71, v69, v63, v65 op_sel:[1,0,0] op_sel_hi:[1,0,0]
    v_mfma_f32_16x16x32_bf16 v[220:223], v[8:11], v[124:127], v[220:223]
    ds_read_b128 v[8:11], v3 offset:40960
    v_and_b32_e64 v68, s34, v59
    v_mfma_f32_16x16x32_bf16 v[224:227], v[12:15], v[120:123], v[224:227]
    v_and_b32 v69, s35, v59
    v_cvt_pk_bf16_f32 v132, v132, v70
    v_mfma_f32_16x16x32_bf16 v[228:231], v[12:15], v[124:127], v[228:231]
    ds_read_b128 v[12:15], v3 offset:43008
    s_waitcnt lgkmcnt(7)
    v_mfma_f32_16x16x32_bf16 v[232:235], v[16:19], v[120:123], v[232:235]
    v_cvt_pk_bf16_f32 v134, v134, v71
    v_fma_mix_f32 v133, v68, v62, v65 op_sel:[0,0,0] op_sel_hi:[1,0,0]
    v_mfma_f32_16x16x32_bf16 v[236:239], v[16:19], v[124:127], v[236:239]
    ds_read_b128 v[16:19], v3 offset:45056
    v_fma_mix_f32 v70, v69, v63, v65 op_sel:[0,0,0] op_sel_hi:[1,0,0]
    v_mfma_f32_16x16x32_bf16 v[240:243], v[20:23], v[120:123], v[240:243]
    v_fma_mix_f32 v135, v68, v62, v65 op_sel:[1,0,0] op_sel_hi:[1,0,0]
    v_fma_mix_f32 v71, v69, v63, v65 op_sel:[1,0,0] op_sel_hi:[1,0,0]
    v_mfma_f32_16x16x32_bf16 v[244:247], v[20:23], v[124:127], v[244:247]
    ds_read_b128 v[20:23], v3 offset:47104
    v_cvt_pk_bf16_f32 v133, v133, v70
    v_mfma_f32_16x16x32_bf16 v[248:251], v[24:27], v[120:123], v[248:251]
    v_cvt_pk_bf16_f32 v135, v135, v71
    v_mfma_f32_16x16x32_bf16 v[252:255], v[24:27], v[124:127], v[252:255]
    ds_read_b128 v[24:27], v3 offset:49152
    s_waitcnt lgkmcnt(7)
    v_mfma_f32_16x16x32_bf16 v[136:139], v[28:31], v[128:131], v[136:139]
    v_and_b32 v68, s34, v48
    v_and_b32 v69, s35, v48
    v_mfma_f32_16x16x32_bf16 v[140:143], v[28:31], v[132:135], v[140:143]
    ds_read_b128 v[28:31], v3 offset:51200
    v_lshrrev_b32 v48, 8, v48
    v_mfma_f32_16x16x32_bf16 v[144:147], v[32:35], v[128:131], v[144:147]
    v_fma_mix_f32 v120, v68, v52, v66 op_sel:[0,0,0] op_sel_hi:[1,0,0]
    v_fma_mix_f32 v70, v69, v53, v66 op_sel:[0,0,0] op_sel_hi:[1,0,0]
    v_mfma_f32_16x16x32_bf16 v[148:151], v[32:35], v[132:135], v[148:151]
    ds_read_b128 v[32:35], v3 offset:53248
    v_fma_mix_f32 v122, v68, v52, v66 op_sel:[1,0,0] op_sel_hi:[1,0,0]
    v_mfma_f32_16x16x32_bf16 v[152:155], v[36:39], v[128:131], v[152:155]
    v_fma_mix_f32 v71, v69, v53, v66 op_sel:[1,0,0] op_sel_hi:[1,0,0]
    v_and_b32 v68, s34, v48
    v_mfma_f32_16x16x32_bf16 v[156:159], v[36:39], v[132:135], v[156:159]
    ds_read_b128 v[36:39], v3 offset:55296
    s_waitcnt lgkmcnt(7)
    v_mfma_f32_16x16x32_bf16 v[160:163], v[40:43], v[128:131], v[160:163]
    v_and_b32_e64 v69, s35, v48
    v_cvt_pk_bf16_f32 v120, v120, v70
    v_mfma_f32_16x16x32_bf16 v[164:167], v[40:43], v[132:135], v[164:167]
    ds_read_b128 v[40:43], v3 offset:57344
    v_mfma_f32_16x16x32_bf16 v[168:171], v[44:47], v[128:131], v[168:171]
    v_cvt_pk_bf16_f32 v122, v122, v71
    v_fma_mix_f32 v121, v68, v52, v66 op_sel:[0,0,0] op_sel_hi:[1,0,0]
    v_mfma_f32_16x16x32_bf16 v[172:175], v[44:47], v[132:135], v[172:175]
    ds_read_b128 v[44:47], v3 offset:59392
    v_fma_mix_f32 v70, v69, v53, v66 op_sel:[0,0,0] op_sel_hi:[1,0,0]
    v_mfma_f32_16x16x32_bf16 v[176:179], v[8:11], v[128:131], v[176:179]
    s_barrier
    v_fma_mix_f32 v123, v68, v52, v66 op_sel:[1,0,0] op_sel_hi:[1,0,0]
    v_mfma_f32_16x16x32_bf16 v[180:183], v[8:11], v[132:135], v[180:183]
    ds_read_b128 v[8:11], v2 offset:0
    s_waitcnt lgkmcnt(7)
    v_mfma_f32_16x16x32_bf16 v[184:187], v[12:15], v[128:131], v[184:187]
    v_fma_mix_f32 v71, v69, v53, v66 op_sel:[1,0,0] op_sel_hi:[1,0,0]
    v_cvt_pk_bf16_f32 v121, v121, v70
    v_mfma_f32_16x16x32_bf16 v[188:191], v[12:15], v[132:135], v[188:191]
    ds_read_b128 v[12:15], v2 offset:2048
    v_cvt_pk_bf16_f32 v123, v123, v71
    v_mfma_f32_16x16x32_bf16 v[192:195], v[16:19], v[128:131], v[192:195]
    v_and_b32_e64 v68, s34, v49
    v_mfma_f32_16x16x32_bf16 v[196:199], v[16:19], v[132:135], v[196:199]
    ds_read_b128 v[16:19], v2 offset:4096
    v_and_b32_e64 v69, s35, v49
    v_mfma_f32_16x16x32_bf16 v[200:203], v[20:23], v[128:131], v[200:203]
    v_lshrrev_b32 v49, 8, v49
    v_fma_mix_f32 v124, v68, v54, v67 op_sel:[0,0,0] op_sel_hi:[1,0,0]
    v_mfma_f32_16x16x32_bf16 v[204:207], v[20:23], v[132:135], v[204:207]
    ds_read_b128 v[20:23], v2 offset:6144
    s_waitcnt lgkmcnt(7)
    v_mfma_f32_16x16x32_bf16 v[208:211], v[24:27], v[128:131], v[208:211]
    v_fma_mix_f32 v70, v69, v55, v67 op_sel:[0,0,0] op_sel_hi:[1,0,0]
    v_fma_mix_f32 v126, v68, v54, v67 op_sel:[1,0,0] op_sel_hi:[1,0,0]
    v_mfma_f32_16x16x32_bf16 v[212:215], v[24:27], v[132:135], v[212:215]
    ds_read_b128 v[24:27], v2 offset:8192
    v_fma_mix_f32 v71, v69, v55, v67 op_sel:[1,0,0] op_sel_hi:[1,0,0]
    v_mfma_f32_16x16x32_bf16 v[216:219], v[28:31], v[128:131], v[216:219]
    v_and_b32_e64 v68, s34, v49
    v_and_b32_e64 v69, s35, v49
    v_mfma_f32_16x16x32_bf16 v[220:223], v[28:31], v[132:135], v[220:223]
    ds_read_b128 v[28:31], v2 offset:10240
    v_mfma_f32_16x16x32_bf16 v[224:227], v[32:35], v[128:131], v[224:227]
    v_cvt_pk_bf16_f32 v124, v124, v70
    v_cvt_pk_bf16_f32 v126, v126, v71
    v_mfma_f32_16x16x32_bf16 v[228:231], v[32:35], v[132:135], v[228:231]
    ds_read_b128 v[32:35], v2 offset:12288
    s_waitcnt lgkmcnt(7)
    v_mfma_f32_16x16x32_bf16 v[232:235], v[36:39], v[128:131], v[232:235]
    s_barrier
    v_fma_mix_f32 v125, v68, v54, v67 op_sel:[0,0,0] op_sel_hi:[1,0,0]
    v_mfma_f32_16x16x32_bf16 v[236:239], v[36:39], v[132:135], v[236:239]
    ds_read_b128 v[36:39], v2 offset:14336
    v_fma_mix_f32 v70, v69, v55, v67 op_sel:[0,0,0] op_sel_hi:[1,0,0]
    v_mfma_f32_16x16x32_bf16 v[240:243], v[40:43], v[128:131], v[240:243]
    v_fma_mix_f32 v127, v68, v54, v67 op_sel:[1,0,0] op_sel_hi:[1,0,0]
    v_fma_mix_f32 v71, v69, v55, v67 op_sel:[1,0,0] op_sel_hi:[1,0,0]
    v_mfma_f32_16x16x32_bf16 v[244:247], v[40:43], v[132:135], v[244:247]
    ds_read_b128 v[40:43], v2 offset:16384
    v_cvt_pk_bf16_f32 v125, v125, v70
    v_mfma_f32_16x16x32_bf16 v[248:251], v[44:47], v[128:131], v[248:251]
    v_cvt_pk_bf16_f32 v127, v127, v71
    v_mfma_f32_16x16x32_bf16 v[252:255], v[44:47], v[132:135], v[252:255]
    ds_read_b128 v[44:47], v2 offset:18432
    s_waitcnt lgkmcnt(7)
    v_mfma_f32_16x16x32_bf16 v[136:139], v[8:11], v[120:123], v[136:139]
    v_and_b32 v68, s34, v50
    v_and_b32_e64 v69, s35, v50
    v_mfma_f32_16x16x32_bf16 v[140:143], v[8:11], v[124:127], v[140:143]
    ds_read_b128 v[8:11], v2 offset:20480
    v_lshrrev_b32_e64 v50, 8, v50
    v_mfma_f32_16x16x32_bf16 v[144:147], v[12:15], v[120:123], v[144:147]
    ds_read2st64_b64 v[56:59], v4 offset0:0 offset1:4
    v_fma_mix_f32 v128, v68, v52, v66 op_sel:[0,0,0] op_sel_hi:[1,0,0]
    v_mfma_f32_16x16x32_bf16 v[148:151], v[12:15], v[124:127], v[148:151]
    ds_read_b128 v[12:15], v2 offset:22528
    v_fma_mix_f32 v70, v69, v53, v66 op_sel:[0,0,0] op_sel_hi:[1,0,0]
    v_mfma_f32_16x16x32_bf16 v[152:155], v[16:19], v[120:123], v[152:155]
    ds_read_b128 v[60:63], v5 offset:0
    v_fma_mix_f32 v130, v68, v52, v66 op_sel:[1,0,0] op_sel_hi:[1,0,0]
    v_mfma_f32_16x16x32_bf16 v[156:159], v[16:19], v[124:127], v[156:159]
    ds_read_b128 v[16:19], v2 offset:24576
    s_waitcnt lgkmcnt(9)
    v_mfma_f32_16x16x32_bf16 v[160:163], v[20:23], v[120:123], v[160:163]
    v_subrev_u32 v5, 3072, v5
    v_fma_mix_f32 v71, v69, v53, v66 op_sel:[1,0,0] op_sel_hi:[1,0,0]
    v_mfma_f32_16x16x32_bf16 v[164:167], v[20:23], v[124:127], v[164:167]
    ds_read_b128 v[20:23], v2 offset:26624
    v_and_b32 v68, s34, v50
    v_mfma_f32_16x16x32_bf16 v[168:171], v[24:27], v[120:123], v[168:171]
    ds_read_b64 v[64:65], v6 offset:0
    v_and_b32_e64 v69, s35, v50
    v_mfma_f32_16x16x32_bf16 v[172:175], v[24:27], v[124:127], v[172:175]
    ds_read_b128 v[24:27], v2 offset:28672
    v_cvt_pk_bf16_f32 v128, v128, v70
    v_mfma_f32_16x16x32_bf16 v[176:179], v[28:31], v[120:123], v[176:179]
    v_subrev_u32 v6, 3072, v6
    v_cvt_pk_bf16_f32 v130, v130, v71
    v_mfma_f32_16x16x32_bf16 v[180:183], v[28:31], v[124:127], v[180:183]
    ds_read_b128 v[28:31], v3 offset:0
    s_waitcnt lgkmcnt(10)
    v_mfma_f32_16x16x32_bf16 v[184:187], v[32:35], v[120:123], v[184:187]
    v_add_u32 v2, s37, v2
    v_fma_mix_f32 v129, v68, v52, v66 op_sel:[0,0,0] op_sel_hi:[1,0,0]
    v_mfma_f32_16x16x32_bf16 v[188:191], v[32:35], v[124:127], v[188:191]
    ds_read_b128 v[32:35], v3 offset:2048
    v_fma_mix_f32 v70, v69, v53, v66 op_sel:[0,0,0] op_sel_hi:[1,0,0]
    v_mfma_f32_16x16x32_bf16 v[192:195], v[36:39], v[120:123], v[192:195]
    v_fma_mix_f32 v131, v68, v52, v66 op_sel:[1,0,0] op_sel_hi:[1,0,0]
    v_fma_mix_f32 v71, v69, v53, v66 op_sel:[1,0,0] op_sel_hi:[1,0,0]
    v_mfma_f32_16x16x32_bf16 v[196:199], v[36:39], v[124:127], v[196:199]
    ds_read_b128 v[36:39], v3 offset:4096
    v_cvt_pk_bf16_f32 v129, v129, v70
    v_mfma_f32_16x16x32_bf16 v[200:203], v[40:43], v[120:123], v[200:203]
    v_cvt_pk_bf16_f32 v131, v131, v71
    v_and_b32 v68, s34, v51
    v_mfma_f32_16x16x32_bf16 v[204:207], v[40:43], v[124:127], v[204:207]
    ds_read_b128 v[40:43], v3 offset:6144
    s_waitcnt lgkmcnt(9)
    v_mfma_f32_16x16x32_bf16 v[208:211], v[44:47], v[120:123], v[208:211]
    v_and_b32 v69, s35, v51
    v_lshrrev_b32 v51, 8, v51
    v_mfma_f32_16x16x32_bf16 v[212:215], v[44:47], v[124:127], v[212:215]
    ds_read_b128 v[44:47], v3 offset:8192
    v_fma_mix_f32 v132, v68, v54, v67 op_sel:[0,0,0] op_sel_hi:[1,0,0]
    v_mfma_f32_16x16x32_bf16 v[216:219], v[8:11], v[120:123], v[216:219]
    v_fma_mix_f32 v70, v69, v55, v67 op_sel:[0,0,0] op_sel_hi:[1,0,0]
    v_fma_mix_f32 v134, v68, v54, v67 op_sel:[1,0,0] op_sel_hi:[1,0,0]
    v_mfma_f32_16x16x32_bf16 v[220:223], v[8:11], v[124:127], v[220:223]
    ds_read_b128 v[8:11], v3 offset:10240
    v_fma_mix_f32 v71, v69, v55, v67 op_sel:[1,0,0] op_sel_hi:[1,0,0]
    v_mfma_f32_16x16x32_bf16 v[224:227], v[12:15], v[120:123], v[224:227]
    v_and_b32_e64 v68, s34, v51
    v_and_b32 v69, s35, v51
    v_mfma_f32_16x16x32_bf16 v[228:231], v[12:15], v[124:127], v[228:231]
    ds_read_b128 v[12:15], v3 offset:12288
    s_waitcnt lgkmcnt(7)
    v_mfma_f32_16x16x32_bf16 v[232:235], v[16:19], v[120:123], v[232:235]
    v_cvt_pk_bf16_f32 v132, v132, v70
    v_cvt_pk_bf16_f32 v134, v134, v71
    v_mfma_f32_16x16x32_bf16 v[236:239], v[16:19], v[124:127], v[236:239]
    ds_read_b128 v[16:19], v3 offset:14336
    v_fma_mix_f32 v133, v68, v54, v67 op_sel:[0,0,0] op_sel_hi:[1,0,0]
    v_mfma_f32_16x16x32_bf16 v[240:243], v[20:23], v[120:123], v[240:243]
    v_fma_mix_f32 v70, v69, v55, v67 op_sel:[0,0,0] op_sel_hi:[1,0,0]
    v_fma_mix_f32 v135, v68, v54, v67 op_sel:[1,0,0] op_sel_hi:[1,0,0]
    v_mfma_f32_16x16x32_bf16 v[244:247], v[20:23], v[124:127], v[244:247]
    ds_read_b128 v[20:23], v3 offset:16384
    v_fma_mix_f32 v71, v69, v55, v67 op_sel:[1,0,0] op_sel_hi:[1,0,0]
    v_mfma_f32_16x16x32_bf16 v[248:251], v[24:27], v[120:123], v[248:251]
    v_cvt_pk_bf16_f32 v133, v133, v70
    v_cvt_pk_bf16_f32 v135, v135, v71
    v_mfma_f32_16x16x32_bf16 v[252:255], v[24:27], v[124:127], v[252:255]
    ds_read_b128 v[24:27], v3 offset:18432
    s_waitcnt lgkmcnt(7)
    v_mfma_f32_16x16x32_bf16 v[136:139], v[28:31], v[128:131], v[136:139]
    v_and_b32 v68, s34, v56
    v_and_b32_e64 v69, s35, v56
    v_mfma_f32_16x16x32_bf16 v[140:143], v[28:31], v[132:135], v[140:143]
    ds_read_b128 v[28:31], v3 offset:20480
    v_lshrrev_b32_e64 v56, 8, v56
    v_mfma_f32_16x16x32_bf16 v[144:147], v[32:35], v[128:131], v[144:147]
    v_fma_mix_f32 v120, v68, v60, v64 op_sel:[0,0,0] op_sel_hi:[1,0,0]
    v_fma_mix_f32 v70, v69, v61, v64 op_sel:[0,0,0] op_sel_hi:[1,0,0]
    v_mfma_f32_16x16x32_bf16 v[148:151], v[32:35], v[132:135], v[148:151]
    ds_read_b128 v[32:35], v3 offset:22528
    v_fma_mix_f32 v122, v68, v60, v64 op_sel:[1,0,0] op_sel_hi:[1,0,0]
    v_mfma_f32_16x16x32_bf16 v[152:155], v[36:39], v[128:131], v[152:155]
    v_fma_mix_f32 v71, v69, v61, v64 op_sel:[1,0,0] op_sel_hi:[1,0,0]
    v_and_b32_e64 v68, s34, v56
    v_mfma_f32_16x16x32_bf16 v[156:159], v[36:39], v[132:135], v[156:159]
    ds_read_b128 v[36:39], v3 offset:24576
    s_waitcnt lgkmcnt(7)
    v_mfma_f32_16x16x32_bf16 v[160:163], v[40:43], v[128:131], v[160:163]
    v_and_b32 v69, s35, v56
    v_cvt_pk_bf16_f32 v120, v120, v70
    v_mfma_f32_16x16x32_bf16 v[164:167], v[40:43], v[132:135], v[164:167]
    ds_read_b128 v[40:43], v3 offset:26624
    v_cvt_pk_bf16_f32 v122, v122, v71
    v_mfma_f32_16x16x32_bf16 v[168:171], v[44:47], v[128:131], v[168:171]
    v_fma_mix_f32 v121, v68, v60, v64 op_sel:[0,0,0] op_sel_hi:[1,0,0]
    v_fma_mix_f32 v70, v69, v61, v64 op_sel:[0,0,0] op_sel_hi:[1,0,0]
    v_mfma_f32_16x16x32_bf16 v[172:175], v[44:47], v[132:135], v[172:175]
    ds_read_b128 v[44:47], v3 offset:28672
    v_fma_mix_f32 v123, v68, v60, v64 op_sel:[1,0,0] op_sel_hi:[1,0,0]
    v_mfma_f32_16x16x32_bf16 v[176:179], v[8:11], v[128:131], v[176:179]
    s_barrier
    v_fma_mix_f32 v71, v69, v61, v64 op_sel:[1,0,0] op_sel_hi:[1,0,0]
    v_mfma_f32_16x16x32_bf16 v[180:183], v[8:11], v[132:135], v[180:183]
    ds_read_b128 v[8:11], v2 offset:30720
    s_waitcnt lgkmcnt(7)
    v_mfma_f32_16x16x32_bf16 v[184:187], v[12:15], v[128:131], v[184:187]
    v_add_u32_e64 v3, s37, v3
    v_cvt_pk_bf16_f32 v121, v121, v70
    v_mfma_f32_16x16x32_bf16 v[188:191], v[12:15], v[132:135], v[188:191]
    ds_read_b128 v[12:15], v2 offset:32768
    v_cvt_pk_bf16_f32 v123, v123, v71
    v_mfma_f32_16x16x32_bf16 v[192:195], v[16:19], v[128:131], v[192:195]
    s_sub_u32 s37, 0, s37
    v_and_b32 v68, s34, v57
    v_mfma_f32_16x16x32_bf16 v[196:199], v[16:19], v[132:135], v[196:199]
    ds_read_b128 v[16:19], v2 offset:34816
    v_and_b32 v69, s35, v57
    v_mfma_f32_16x16x32_bf16 v[200:203], v[20:23], v[128:131], v[200:203]
    s_sub_u32 s36, s36, 1
    v_lshrrev_b32 v57, 8, v57
    v_mfma_f32_16x16x32_bf16 v[204:207], v[20:23], v[132:135], v[204:207]
    ds_read_b128 v[20:23], v2 offset:36864
    s_waitcnt lgkmcnt(7)
    v_mfma_f32_16x16x32_bf16 v[208:211], v[24:27], v[128:131], v[208:211]
    v_fma_mix_f32 v124, v68, v62, v65 op_sel:[0,0,0] op_sel_hi:[1,0,0]
    v_fma_mix_f32 v70, v69, v63, v65 op_sel:[0,0,0] op_sel_hi:[1,0,0]
    v_mfma_f32_16x16x32_bf16 v[212:215], v[24:27], v[132:135], v[212:215]
    ds_read_b128 v[24:27], v2 offset:38912
    v_fma_mix_f32 v126, v68, v62, v65 op_sel:[1,0,0] op_sel_hi:[1,0,0]
    v_mfma_f32_16x16x32_bf16 v[216:219], v[28:31], v[128:131], v[216:219]
    v_fma_mix_f32 v71, v69, v63, v65 op_sel:[1,0,0] op_sel_hi:[1,0,0]
    v_and_b32 v68, s34, v57
    v_mfma_f32_16x16x32_bf16 v[220:223], v[28:31], v[132:135], v[220:223]
    ds_read_b128 v[28:31], v2 offset:40960
    v_and_b32 v69, s35, v57
    v_mfma_f32_16x16x32_bf16 v[224:227], v[32:35], v[128:131], v[224:227]
    v_cvt_pk_bf16_f32 v124, v124, v70
    v_cvt_pk_bf16_f32 v126, v126, v71
    v_mfma_f32_16x16x32_bf16 v[228:231], v[32:35], v[132:135], v[228:231]
    ds_read_b128 v[32:35], v2 offset:43008
    s_waitcnt lgkmcnt(7)
    v_mfma_f32_16x16x32_bf16 v[232:235], v[36:39], v[128:131], v[232:235]
    s_barrier
    v_fma_mix_f32 v125, v68, v62, v65 op_sel:[0,0,0] op_sel_hi:[1,0,0]
    v_mfma_f32_16x16x32_bf16 v[236:239], v[36:39], v[132:135], v[236:239]
    ds_read_b128 v[36:39], v2 offset:45056
    v_fma_mix_f32 v70, v69, v63, v65 op_sel:[0,0,0] op_sel_hi:[1,0,0]
    v_mfma_f32_16x16x32_bf16 v[240:243], v[40:43], v[128:131], v[240:243]
    v_fma_mix_f32 v127, v68, v62, v65 op_sel:[1,0,0] op_sel_hi:[1,0,0]
    v_fma_mix_f32 v71, v69, v63, v65 op_sel:[1,0,0] op_sel_hi:[1,0,0]
    v_mfma_f32_16x16x32_bf16 v[244:247], v[40:43], v[132:135], v[244:247]
    ds_read_b128 v[40:43], v2 offset:47104
    v_cvt_pk_bf16_f32 v125, v125, v70
    v_mfma_f32_16x16x32_bf16 v[248:251], v[44:47], v[128:131], v[248:251]
    v_cvt_pk_bf16_f32 v127, v127, v71
    v_mfma_f32_16x16x32_bf16 v[252:255], v[44:47], v[132:135], v[252:255]
    ds_read_b128 v[44:47], v2 offset:49152
    s_waitcnt lgkmcnt(7)
    s_cbranch_scc0 L_loop15
L_tail:
    ds_read_b128 v[40:43], v2 offset:0
    ds_read_b128 v[44:47], v3 offset:0
    v_mfma_f32_16x16x32_bf16 v[136:139], v[8:11], v[120:123], v[136:139]
    v_and_b32 v68, s34, v58
    v_and_b32 v69, s35, v58
    v_mfma_f32_16x16x32_bf16 v[140:143], v[8:11], v[124:127], v[140:143]
    ds_read_b128 v[8:11], v0 offset:38912
    v_lshrrev_b32_e64 v58, 8, v58
    v_mfma_f32_16x16x32_bf16 v[144:147], v[12:15], v[120:123], v[144:147]
    v_fma_mix_f32 v128, v68, v60, v64 op_sel:[0,0,0] op_sel_hi:[1,0,0]
    v_fma_mix_f32 v70, v69, v61, v64 op_sel:[0,0,0] op_sel_hi:[1,0,0]
    v_mfma_f32_16x16x32_bf16 v[148:151], v[12:15], v[124:127], v[148:151]
    ds_read_b128 v[12:15], v1 offset:38912
    v_fma_mix_f32 v130, v68, v60, v64 op_sel:[1,0,0] op_sel_hi:[1,0,0]
    v_mfma_f32_16x16x32_bf16 v[152:155], v[16:19], v[120:123], v[152:155]
    v_fma_mix_f32 v71, v69, v61, v64 op_sel:[1,0,0] op_sel_hi:[1,0,0]
    v_and_b32 v68, s34, v58
    v_mfma_f32_16x16x32_bf16 v[156:159], v[16:19], v[124:127], v[156:159]
    ds_read_b128 v[16:19], v0 offset:0
    s_waitcnt lgkmcnt(7)
    v_mfma_f32_16x16x32_bf16 v[160:163], v[20:23], v[120:123], v[160:163]
    v_and_b32_e64 v69, s35, v58
    v_cvt_pk_bf16_f32 v128, v128, v70
    v_mfma_f32_16x16x32_bf16 v[164:167], v[20:23], v[124:127], v[164:167]
    ds_read_b128 v[20:23], v1 offset:0
    v_cvt_pk_bf16_f32 v130, v130, v71
    v_mfma_f32_16x16x32_bf16 v[168:171], v[24:27], v[120:123], v[168:171]
    v_fma_mix_f32 v129, v68, v60, v64 op_sel:[0,0,0] op_sel_hi:[1,0,0]
    v_fma_mix_f32 v70, v69, v61, v64 op_sel:[0,0,0] op_sel_hi:[1,0,0]
    v_mfma_f32_16x16x32_bf16 v[172:175], v[24:27], v[124:127], v[172:175]
    ds_read_b128 v[24:27], v3 offset:30720
    v_fma_mix_f32 v131, v68, v60, v64 op_sel:[1,0,0] op_sel_hi:[1,0,0]
    v_mfma_f32_16x16x32_bf16 v[176:179], v[28:31], v[120:123], v[176:179]
    v_fma_mix_f32 v71, v69, v61, v64 op_sel:[1,0,0] op_sel_hi:[1,0,0]
    v_cvt_pk_bf16_f32 v129, v129, v70
    v_mfma_f32_16x16x32_bf16 v[180:183], v[28:31], v[124:127], v[180:183]
    ds_read_b128 v[28:31], v2 offset:2048
    s_waitcnt lgkmcnt(7)
    v_mfma_f32_16x16x32_bf16 v[184:187], v[32:35], v[120:123], v[184:187]
    v_cvt_pk_bf16_f32 v131, v131, v71
    v_and_b32 v68, s34, v59
    v_mfma_f32_16x16x32_bf16 v[188:191], v[32:35], v[124:127], v[188:191]
    ds_read_b128 v[32:35], v3 offset:2048
    v_and_b32 v69, s35, v59
    v_mfma_f32_16x16x32_bf16 v[192:195], v[36:39], v[120:123], v[192:195]
    v_lshrrev_b32 v59, 8, v59
    v_fma_mix_f32 v132, v68, v62, v65 op_sel:[0,0,0] op_sel_hi:[1,0,0]
    v_mfma_f32_16x16x32_bf16 v[196:199], v[36:39], v[124:127], v[196:199]
    ds_read_b128 v[36:39], v0 offset:40960
    v_fma_mix_f32 v70, v69, v63, v65 op_sel:[0,0,0] op_sel_hi:[1,0,0]
    v_mfma_f32_16x16x32_bf16 v[136:139], v[40:43], v[72:75], v[136:139]
    v_fma_mix_f32 v134, v68, v62, v65 op_sel:[1,0,0] op_sel_hi:[1,0,0]
    v_fma_mix_f32 v71, v69, v63, v65 op_sel:[1,0,0] op_sel_hi:[1,0,0]
    v_mfma_f32_16x16x32_bf16 v[140:143], v[40:43], v[76:79], v[140:143]
    ds_read_b128 v[40:43], v1 offset:40960
    s_waitcnt lgkmcnt(6)
    v_mfma_f32_16x16x32_bf16 v[136:139], v[44:47], v[80:83], v[136:139]
    v_and_b32 v68, s34, v59
    v_and_b32_e64 v69, s35, v59
    v_mfma_f32_16x16x32_bf16 v[140:143], v[44:47], v[84:87], v[140:143]
    ds_read_b128 v[44:47], v0 offset:2048
    v_cvt_pk_bf16_f32 v132, v132, v70
    v_mfma_f32_16x16x32_bf16 v[136:139], v[8:11], v[88:91], v[136:139]
    v_cvt_pk_bf16_f32 v134, v134, v71
    v_fma_mix_f32 v133, v68, v62, v65 op_sel:[0,0,0] op_sel_hi:[1,0,0]
    v_mfma_f32_16x16x32_bf16 v[140:143], v[8:11], v[92:95], v[140:143]
    ds_read_b128 v[8:11], v1 offset:2048
    v_fma_mix_f32 v70, v69, v63, v65 op_sel:[0,0,0] op_sel_hi:[1,0,0]
    v_mfma_f32_16x16x32_bf16 v[136:139], v[12:15], v[96:99], v[136:139]
    v_fma_mix_f32 v135, v68, v62, v65 op_sel:[1,0,0] op_sel_hi:[1,0,0]
    v_fma_mix_f32 v71, v69, v63, v65 op_sel:[1,0,0] op_sel_hi:[1,0,0]
    v_mfma_f32_16x16x32_bf16 v[140:143], v[12:15], v[100:103], v[140:143]
    ds_read_b128 v[12:15], v3 offset:32768
    v_cvt_pk_bf16_f32 v133, v133, v70
    v_mfma_f32_16x16x32_bf16 v[136:139], v[16:19], v[104:107], v[136:139]
    v_cvt_pk_bf16_f32 v135, v135, v71
    v_add_u32 v6, 7168, v7
    v_mfma_f32_16x16x32_bf16 v[140:143], v[16:19], v[108:111], v[140:143]
    ds_read_b128 v[16:19], v2 offset:4096
    s_waitcnt lgkmcnt(6)
    v_mfma_f32_16x16x32_bf16 v[136:139], v[20:23], v[112:115], v[136:139]
    v_add_u32 v5, 14336, v7
    v_add_u32 v4, 21504, v7
    v_mfma_f32_16x16x32_bf16 v[140:143], v[20:23], v[116:119], v[140:143]
    ds_read_b128 v[20:23], v3 offset:4096
    v_add_u32 v48, -30720, v2
    v_mfma_f32_16x16x32_bf16 v[136:139], v[24:27], v[128:131], v[136:139]
    v_add_u32 v49, -30720, v3
    s_add_u32 s38, s40, 114688
    v_mfma_f32_16x16x32_bf16 v[140:143], v[24:27], v[132:135], v[140:143]
    ds_read_b128 v[24:27], v0 offset:43008
    v_mfma_f32_16x16x32_bf16 v[144:147], v[28:31], v[72:75], v[144:147]
    v_mfma_f32_16x16x32_bf16 v[148:151], v[28:31], v[76:79], v[148:151]
    ds_read_b128 v[28:31], v1 offset:43008
    v_mfma_f32_16x16x32_bf16 v[144:147], v[32:35], v[80:83], v[144:147]
    v_cvt_pk_bf16_f32 v136, v136, v140
    v_cvt_pk_bf16_f32 v137, v137, v141
    v_mfma_f32_16x16x32_bf16 v[148:151], v[32:35], v[84:87], v[148:151]
    ds_read_b128 v[32:35], v0 offset:4096
    s_waitcnt lgkmcnt(6)
    v_mfma_f32_16x16x32_bf16 v[144:147], v[36:39], v[88:91], v[144:147]
    buffer_store_dword v136, v7, s[20:23], s38 offen sc0 sc1
    v_mfma_f32_16x16x32_bf16 v[148:151], v[36:39], v[92:95], v[148:151]
    ds_read_b128 v[36:39], v1 offset:4096
    v_cvt_pk_bf16_f32 v138, v138, v142
    v_mfma_f32_16x16x32_bf16 v[144:147], v[40:43], v[96:99], v[144:147]
    buffer_store_dword v137, v6, s[20:23], s38 offen sc0 sc1
    v_mfma_f32_16x16x32_bf16 v[148:151], v[40:43], v[100:103], v[148:151]
    ds_read_b128 v[40:43], v3 offset:34816
    v_cvt_pk_bf16_f32 v139, v139, v143
    v_mfma_f32_16x16x32_bf16 v[144:147], v[44:47], v[104:107], v[144:147]
    buffer_store_dword v138, v5, s[20:23], s38 offen sc0 sc1
    v_mfma_f32_16x16x32_bf16 v[148:151], v[44:47], v[108:111], v[148:151]
    ds_read_b128 v[44:47], v2 offset:6144
    s_add_u32 s40, s38, 114688
    v_mfma_f32_16x16x32_bf16 v[144:147], v[8:11], v[112:115], v[144:147]
    buffer_store_dword v139, v4, s[20:23], s38 offen sc0 sc1
    v_mfma_f32_16x16x32_bf16 v[148:151], v[8:11], v[116:119], v[148:151]
    ds_read_b128 v[8:11], v3 offset:6144
    s_waitcnt lgkmcnt(6)
    v_mfma_f32_16x16x32_bf16 v[144:147], v[12:15], v[128:131], v[144:147]
    v_mfma_f32_16x16x32_bf16 v[148:151], v[12:15], v[132:135], v[148:151]
    ds_read_b128 v[12:15], v0 offset:45056
    v_mfma_f32_16x16x32_bf16 v[152:155], v[16:19], v[72:75], v[152:155]
    v_mfma_f32_16x16x32_bf16 v[156:159], v[16:19], v[76:79], v[156:159]
    ds_read_b128 v[16:19], v1 offset:45056
    v_mfma_f32_16x16x32_bf16 v[152:155], v[20:23], v[80:83], v[152:155]
    v_cvt_pk_bf16_f32 v144, v144, v148
    v_cvt_pk_bf16_f32 v145, v145, v149
    v_mfma_f32_16x16x32_bf16 v[156:159], v[20:23], v[84:87], v[156:159]
    ds_read_b128 v[20:23], v0 offset:6144
    v_cvt_pk_bf16_f32 v146, v146, v150
    v_mfma_f32_16x16x32_bf16 v[152:155], v[24:27], v[88:91], v[152:155]
    buffer_store_dword v144, v7, s[20:23], s40 offen sc0 sc1
    v_mfma_f32_16x16x32_bf16 v[156:159], v[24:27], v[92:95], v[156:159]
    ds_read_b128 v[24:27], v1 offset:6144
    s_waitcnt lgkmcnt(6)
    v_mfma_f32_16x16x32_bf16 v[152:155], v[28:31], v[96:99], v[152:155]
    buffer_store_dword v145, v6, s[20:23], s40 offen sc0 sc1
    v_mfma_f32_16x16x32_bf16 v[156:159], v[28:31], v[100:103], v[156:159]
    ds_read_b128 v[28:31], v3 offset:36864
    v_cvt_pk_bf16_f32 v147, v147, v151
    v_mfma_f32_16x16x32_bf16 v[152:155], v[32:35], v[104:107], v[152:155]
    buffer_store_dword v146, v5, s[20:23], s40 offen sc0 sc1
    v_mfma_f32_16x16x32_bf16 v[156:159], v[32:35], v[108:111], v[156:159]
    ds_read_b128 v[32:35], v2 offset:8192
    s_add_u32 s38, s40, 114688
    v_mfma_f32_16x16x32_bf16 v[152:155], v[36:39], v[112:115], v[152:155]
    buffer_store_dword v147, v4, s[20:23], s40 offen sc0 sc1
    v_mfma_f32_16x16x32_bf16 v[156:159], v[36:39], v[116:119], v[156:159]
    ds_read_b128 v[36:39], v3 offset:8192
    v_mfma_f32_16x16x32_bf16 v[152:155], v[40:43], v[128:131], v[152:155]
    s_barrier
    v_mfma_f32_16x16x32_bf16 v[156:159], v[40:43], v[132:135], v[156:159]
    ds_read_b128 v[40:43], v0 offset:47104
    s_waitcnt lgkmcnt(6)
    v_mfma_f32_16x16x32_bf16 v[160:163], v[44:47], v[72:75], v[160:163]
    v_mfma_f32_16x16x32_bf16 v[164:167], v[44:47], v[76:79], v[164:167]
    ds_read_b128 v[44:47], v1 offset:47104
    v_mfma_f32_16x16x32_bf16 v[160:163], v[8:11], v[80:83], v[160:163]
    v_cvt_pk_bf16_f32 v152, v152, v156
    v_cvt_pk_bf16_f32 v153, v153, v157
    v_mfma_f32_16x16x32_bf16 v[164:167], v[8:11], v[84:87], v[164:167]
    ds_read_b128 v[8:11], v0 offset:8192
    v_cvt_pk_bf16_f32 v154, v154, v158
    v_mfma_f32_16x16x32_bf16 v[160:163], v[12:15], v[88:91], v[160:163]
    buffer_store_dword v152, v7, s[20:23], s38 offen sc0 sc1
    v_mfma_f32_16x16x32_bf16 v[164:167], v[12:15], v[92:95], v[164:167]
    ds_read_b128 v[12:15], v1 offset:8192
    v_cvt_pk_bf16_f32 v155, v155, v159
    v_mfma_f32_16x16x32_bf16 v[160:163], v[16:19], v[96:99], v[160:163]
    buffer_store_dword v153, v6, s[20:23], s38 offen sc0 sc1
    v_mfma_f32_16x16x32_bf16 v[164:167], v[16:19], v[100:103], v[164:167]
    ds_read_b128 v[16:19], v3 offset:38912
    s_waitcnt lgkmcnt(6)
    v_mfma_f32_16x16x32_bf16 v[160:163], v[20:23], v[104:107], v[160:163]
    buffer_store_dword v154, v5, s[20:23], s38 offen sc0 sc1
    v_mfma_f32_16x16x32_bf16 v[164:167], v[20:23], v[108:111], v[164:167]
    ds_read_b128 v[20:23], v2 offset:10240
    s_add_u32 s40, s38, 114688
    v_mfma_f32_16x16x32_bf16 v[160:163], v[24:27], v[112:115], v[160:163]
    buffer_store_dword v155, v4, s[20:23], s38 offen sc0 sc1
    v_mfma_f32_16x16x32_bf16 v[164:167], v[24:27], v[116:119], v[164:167]
    ds_read_b128 v[24:27], v3 offset:10240
    v_mfma_f32_16x16x32_bf16 v[160:163], v[28:31], v[128:131], v[160:163]
    v_mfma_f32_16x16x32_bf16 v[164:167], v[28:31], v[132:135], v[164:167]
    ds_read_b128 v[28:31], v0 offset:49152
    v_mfma_f32_16x16x32_bf16 v[168:171], v[32:35], v[72:75], v[168:171]
    v_mfma_f32_16x16x32_bf16 v[172:175], v[32:35], v[76:79], v[172:175]
    ds_read_b128 v[32:35], v1 offset:49152
    s_waitcnt lgkmcnt(6)
    v_mfma_f32_16x16x32_bf16 v[168:171], v[36:39], v[80:83], v[168:171]
    v_cvt_pk_bf16_f32 v160, v160, v164
    v_cvt_pk_bf16_f32 v161, v161, v165
    v_mfma_f32_16x16x32_bf16 v[172:175], v[36:39], v[84:87], v[172:175]
    ds_read_b128 v[36:39], v0 offset:10240
    v_cvt_pk_bf16_f32 v162, v162, v166
    v_mfma_f32_16x16x32_bf16 v[168:171], v[40:43], v[88:91], v[168:171]
    buffer_store_dword v160, v7, s[20:23], s40 offen sc0 sc1
    v_mfma_f32_16x16x32_bf16 v[172:175], v[40:43], v[92:95], v[172:175]
    ds_read_b128 v[40:43], v1 offset:10240
    v_cvt_pk_bf16_f32 v163, v163, v167
    v_mfma_f32_16x16x32_bf16 v[168:171], v[44:47], v[96:99], v[168:171]
    buffer_store_dword v161, v6, s[20:23], s40 offen sc0 sc1
    v_mfma_f32_16x16x32_bf16 v[172:175], v[44:47], v[100:103], v[172:175]
    ds_read_b128 v[44:47], v3 offset:40960
    v_mfma_f32_16x16x32_bf16 v[168:171], v[8:11], v[104:107], v[168:171]
    buffer_store_dword v162, v5, s[20:23], s40 offen sc0 sc1
    v_mfma_f32_16x16x32_bf16 v[172:175], v[8:11], v[108:111], v[172:175]
    ds_read_b128 v[8:11], v2 offset:12288
    s_waitcnt lgkmcnt(6)
    v_mfma_f32_16x16x32_bf16 v[168:171], v[12:15], v[112:115], v[168:171]
    buffer_store_dword v163, v4, s[20:23], s40 offen sc0 sc1
    v_mfma_f32_16x16x32_bf16 v[172:175], v[12:15], v[116:119], v[172:175]
    ds_read_b128 v[12:15], v3 offset:12288
    s_add_u32 s38, s40, 114688
    v_mfma_f32_16x16x32_bf16 v[168:171], v[16:19], v[128:131], v[168:171]
    v_mfma_f32_16x16x32_bf16 v[172:175], v[16:19], v[132:135], v[172:175]
    ds_read_b128 v[16:19], v0 offset:51200
    v_mfma_f32_16x16x32_bf16 v[176:179], v[20:23], v[72:75], v[176:179]
    v_mfma_f32_16x16x32_bf16 v[180:183], v[20:23], v[76:79], v[180:183]
    ds_read_b128 v[20:23], v1 offset:51200
    v_mfma_f32_16x16x32_bf16 v[176:179], v[24:27], v[80:83], v[176:179]
    v_cvt_pk_bf16_f32 v168, v168, v172
    v_cvt_pk_bf16_f32 v169, v169, v173
    v_mfma_f32_16x16x32_bf16 v[180:183], v[24:27], v[84:87], v[180:183]
    ds_read_b128 v[24:27], v0 offset:12288
    s_waitcnt lgkmcnt(6)
    v_mfma_f32_16x16x32_bf16 v[176:179], v[28:31], v[88:91], v[176:179]
    buffer_store_dword v168, v7, s[20:23], s38 offen sc0 sc1
    v_mfma_f32_16x16x32_bf16 v[180:183], v[28:31], v[92:95], v[180:183]
    ds_read_b128 v[28:31], v1 offset:12288
    v_cvt_pk_bf16_f32 v170, v170, v174
    v_mfma_f32_16x16x32_bf16 v[176:179], v[32:35], v[96:99], v[176:179]
    buffer_store_dword v169, v6, s[20:23], s38 offen sc0 sc1
    v_mfma_f32_16x16x32_bf16 v[180:183], v[32:35], v[100:103], v[180:183]
    ds_read_b128 v[32:35], v3 offset:43008
    v_cvt_pk_bf16_f32 v171, v171, v175
    v_mfma_f32_16x16x32_bf16 v[176:179], v[36:39], v[104:107], v[176:179]
    buffer_store_dword v170, v5, s[20:23], s38 offen sc0 sc1
    v_mfma_f32_16x16x32_bf16 v[180:183], v[36:39], v[108:111], v[180:183]
    ds_read_b128 v[36:39], v2 offset:14336
    s_add_u32 s40, s38, 114688
    v_mfma_f32_16x16x32_bf16 v[176:179], v[40:43], v[112:115], v[176:179]
    buffer_store_dword v171, v4, s[20:23], s38 offen sc0 sc1
    v_mfma_f32_16x16x32_bf16 v[180:183], v[40:43], v[116:119], v[180:183]
    ds_read_b128 v[40:43], v3 offset:14336
    s_waitcnt lgkmcnt(6)
    v_mfma_f32_16x16x32_bf16 v[176:179], v[44:47], v[128:131], v[176:179]
    v_mfma_f32_16x16x32_bf16 v[180:183], v[44:47], v[132:135], v[180:183]
    ds_read_b128 v[44:47], v0 offset:53248
    v_mfma_f32_16x16x32_bf16 v[184:187], v[8:11], v[72:75], v[184:187]
    v_mfma_f32_16x16x32_bf16 v[188:191], v[8:11], v[76:79], v[188:191]
    ds_read_b128 v[8:11], v1 offset:53248
    v_mfma_f32_16x16x32_bf16 v[184:187], v[12:15], v[80:83], v[184:187]
    v_cvt_pk_bf16_f32 v176, v176, v180
    v_cvt_pk_bf16_f32 v177, v177, v181
    v_mfma_f32_16x16x32_bf16 v[188:191], v[12:15], v[84:87], v[188:191]
    ds_read_b128 v[12:15], v0 offset:14336
    v_cvt_pk_bf16_f32 v178, v178, v182
    v_mfma_f32_16x16x32_bf16 v[184:187], v[16:19], v[88:91], v[184:187]
    buffer_store_dword v176, v7, s[20:23], s40 offen sc0 sc1
    v_mfma_f32_16x16x32_bf16 v[188:191], v[16:19], v[92:95], v[188:191]
    ds_read_b128 v[16:19], v1 offset:14336
    s_waitcnt lgkmcnt(6)
    v_mfma_f32_16x16x32_bf16 v[184:187], v[20:23], v[96:99], v[184:187]
    buffer_store_dword v177, v6, s[20:23], s40 offen sc0 sc1
    v_mfma_f32_16x16x32_bf16 v[188:191], v[20:23], v[100:103], v[188:191]
    ds_read_b128 v[20:23], v3 offset:45056
    v_cvt_pk_bf16_f32 v179, v179, v183
    v_mfma_f32_16x16x32_bf16 v[184:187], v[24:27], v[104:107], v[184:187]
    buffer_store_dword v178, v5, s[20:23], s40 offen sc0 sc1
    v_mfma_f32_16x16x32_bf16 v[188:191], v[24:27], v[108:111], v[188:191]
    ds_read_b128 v[24:27], v2 offset:47104
    s_add_u32 s38, s40, 114688
    v_mfma_f32_16x16x32_bf16 v[184:187], v[28:31], v[112:115], v[184:187]
    buffer_store_dword v179, v4, s[20:23], s40 offen sc0 sc1
    v_mfma_f32_16x16x32_bf16 v[188:191], v[28:31], v[116:119], v[188:191]
    ds_read_b128 v[28:31], v2 offset:16384
    v_mfma_f32_16x16x32_bf16 v[184:187], v[32:35], v[128:131], v[184:187]
    v_mfma_f32_16x16x32_bf16 v[188:191], v[32:35], v[132:135], v[188:191]
    ds_read_b128 v[32:35], v3 offset:16384
    s_waitcnt lgkmcnt(6)
    v_mfma_f32_16x16x32_bf16 v[192:195], v[36:39], v[72:75], v[192:195]
    s_barrier
    v_mfma_f32_16x16x32_bf16 v[196:199], v[36:39], v[76:79], v[196:199]
    ds_read_b128 v[36:39], v0 offset:55296
    v_mfma_f32_16x16x32_bf16 v[192:195], v[40:43], v[80:83], v[192:195]
    v_cvt_pk_bf16_f32 v184, v184, v188
    v_cvt_pk_bf16_f32 v185, v185, v189
    v_mfma_f32_16x16x32_bf16 v[196:199], v[40:43], v[84:87], v[196:199]
    ds_read_b128 v[40:43], v1 offset:55296
    v_cvt_pk_bf16_f32 v186, v186, v190
    v_mfma_f32_16x16x32_bf16 v[192:195], v[44:47], v[88:91], v[192:195]
    buffer_store_dword v184, v7, s[20:23], s38 offen sc0 sc1
    v_mfma_f32_16x16x32_bf16 v[196:199], v[44:47], v[92:95], v[196:199]
    ds_read_b128 v[44:47], v0 offset:16384
    v_cvt_pk_bf16_f32 v187, v187, v191
    v_mfma_f32_16x16x32_bf16 v[192:195], v[8:11], v[96:99], v[192:195]
    buffer_store_dword v185, v6, s[20:23], s38 offen sc0 sc1
    v_mfma_f32_16x16x32_bf16 v[196:199], v[8:11], v[100:103], v[196:199]
    ds_read_b128 v[8:11], v1 offset:16384
    s_waitcnt lgkmcnt(6)
    v_mfma_f32_16x16x32_bf16 v[192:195], v[12:15], v[104:107], v[192:195]
    buffer_store_dword v186, v5, s[20:23], s38 offen sc0 sc1
    v_mfma_f32_16x16x32_bf16 v[196:199], v[12:15], v[108:111], v[196:199]
    ds_read_b128 v[12:15], v3 offset:47104
    s_add_u32 s40, s38, 114688
    v_mfma_f32_16x16x32_bf16 v[192:195], v[16:19], v[112:115], v[192:195]
    buffer_store_dword v187, v4, s[20:23], s38 offen sc0 sc1
    v_mfma_f32_16x16x32_bf16 v[196:199], v[16:19], v[116:119], v[196:199]
    ds_read_b128 v[16:19], v2 offset:49152
    v_mfma_f32_16x16x32_bf16 v[192:195], v[20:23], v[128:131], v[192:195]
    v_mfma_f32_16x16x32_bf16 v[196:199], v[20:23], v[132:135], v[196:199]
    ds_read_b128 v[20:23], v2 offset:18432
    v_mfma_f32_16x16x32_bf16 v[200:203], v[24:27], v[120:123], v[200:203]
    v_mfma_f32_16x16x32_bf16 v[204:207], v[24:27], v[124:127], v[204:207]
    ds_read_b128 v[24:27], v3 offset:18432
    s_waitcnt lgkmcnt(6)
    v_mfma_f32_16x16x32_bf16 v[200:203], v[28:31], v[72:75], v[200:203]
    v_cvt_pk_bf16_f32 v192, v192, v196
    v_cvt_pk_bf16_f32 v193, v193, v197
    v_mfma_f32_16x16x32_bf16 v[204:207], v[28:31], v[76:79], v[204:207]
    ds_read_b128 v[28:31], v0 offset:57344
    v_cvt_pk_bf16_f32 v194, v194, v198
    v_mfma_f32_16x16x32_bf16 v[200:203], v[32:35], v[80:83], v[200:203]
    buffer_store_dword v192, v7, s[20:23], s40 offen sc0 sc1
    v_mfma_f32_16x16x32_bf16 v[204:207], v[32:35], v[84:87], v[204:207]
    ds_read_b128 v[32:35], v1 offset:57344
    v_cvt_pk_bf16_f32 v195, v195, v199
    v_mfma_f32_16x16x32_bf16 v[200:203], v[36:39], v[88:91], v[200:203]
    buffer_store_dword v193, v6, s[20:23], s40 offen sc0 sc1
    v_mfma_f32_16x16x32_bf16 v[204:207], v[36:39], v[92:95], v[204:207]
    ds_read_b128 v[36:39], v0 offset:18432
    v_mfma_f32_16x16x32_bf16 v[200:203], v[40:43], v[96:99], v[200:203]
    buffer_store_dword v194, v5, s[20:23], s40 offen sc0 sc1
    v_mfma_f32_16x16x32_bf16 v[204:207], v[40:43], v[100:103], v[204:207]
    ds_read_b128 v[40:43], v1 offset:18432
    s_waitcnt lgkmcnt(6)
    v_mfma_f32_16x16x32_bf16 v[200:203], v[44:47], v[104:107], v[200:203]
    buffer_store_dword v195, v4, s[20:23], s40 offen sc0 sc1
    v_mfma_f32_16x16x32_bf16 v[204:207], v[44:47], v[108:111], v[204:207]
    ds_read_b128 v[44:47], v3 offset:49152
    s_add_u32 s38, s40, 114688
    v_mfma_f32_16x16x32_bf16 v[200:203], v[8:11], v[112:115], v[200:203]
    v_mfma_f32_16x16x32_bf16 v[204:207], v[8:11], v[116:119], v[204:207]
    ds_read_b128 v[8:11], v2 offset:51200
    v_mfma_f32_16x16x32_bf16 v[200:203], v[12:15], v[128:131], v[200:203]
    v_mfma_f32_16x16x32_bf16 v[204:207], v[12:15], v[132:135], v[204:207]
    ds_read_b128 v[12:15], v2 offset:20480
    v_mfma_f32_16x16x32_bf16 v[208:211], v[16:19], v[120:123], v[208:211]
    v_mfma_f32_16x16x32_bf16 v[212:215], v[16:19], v[124:127], v[212:215]
    ds_read_b128 v[16:19], v3 offset:20480
    s_waitcnt lgkmcnt(6)
    v_mfma_f32_16x16x32_bf16 v[208:211], v[20:23], v[72:75], v[208:211]
    v_cvt_pk_bf16_f32 v200, v200, v204
    v_cvt_pk_bf16_f32 v201, v201, v205
    v_mfma_f32_16x16x32_bf16 v[212:215], v[20:23], v[76:79], v[212:215]
    ds_read_b128 v[20:23], v0 offset:59392
    v_cvt_pk_bf16_f32 v202, v202, v206
    v_mfma_f32_16x16x32_bf16 v[208:211], v[24:27], v[80:83], v[208:211]
    buffer_store_dword v200, v7, s[20:23], s38 offen sc0 sc1
    v_mfma_f32_16x16x32_bf16 v[212:215], v[24:27], v[84:87], v[212:215]
    ds_read_b128 v[24:27], v1 offset:59392
    v_cvt_pk_bf16_f32 v203, v203, v207
    v_mfma_f32_16x16x32_bf16 v[208:211], v[28:31], v[88:91], v[208:211]
    buffer_store_dword v201, v6, s[20:23], s38 offen sc0 sc1
    v_mfma_f32_16x16x32_bf16 v[212:215], v[28:31], v[92:95], v[212:215]
    ds_read_b128 v[28:31], v0 offset:20480
    v_mfma_f32_16x16x32_bf16 v[208:211], v[32:35], v[96:99], v[208:211]
    buffer_store_dword v202, v5, s[20:23], s38 offen sc0 sc1
    v_mfma_f32_16x16x32_bf16 v[212:215], v[32:35], v[100:103], v[212:215]
    ds_read_b128 v[32:35], v1 offset:20480
    s_waitcnt lgkmcnt(6)
    v_mfma_f32_16x16x32_bf16 v[208:211], v[36:39], v[104:107], v[208:211]
    buffer_store_dword v203, v4, s[20:23], s38 offen sc0 sc1
    v_mfma_f32_16x16x32_bf16 v[212:215], v[36:39], v[108:111], v[212:215]
    ds_read_b128 v[36:39], v3 offset:51200
    s_add_u32 s40, s38, 114688
    v_mfma_f32_16x16x32_bf16 v[208:211], v[40:43], v[112:115], v[208:211]
    v_mfma_f32_16x16x32_bf16 v[212:215], v[40:43], v[116:119], v[212:215]
    ds_read_b128 v[40:43], v2 offset:53248
    v_mfma_f32_16x16x32_bf16 v[208:211], v[44:47], v[128:131], v[208:211]
    v_mfma_f32_16x16x32_bf16 v[212:215], v[44:47], v[132:135], v[212:215]
    ds_read_b128 v[44:47], v2 offset:22528
    v_mfma_f32_16x16x32_bf16 v[216:219], v[8:11], v[120:123], v[216:219]
    v_mfma_f32_16x16x32_bf16 v[220:223], v[8:11], v[124:127], v[220:223]
    ds_read_b128 v[8:11], v3 offset:22528
    s_waitcnt lgkmcnt(6)
    v_mfma_f32_16x16x32_bf16 v[216:219], v[12:15], v[72:75], v[216:219]
    v_cvt_pk_bf16_f32 v208, v208, v212
    v_cvt_pk_bf16_f32 v209, v209, v213
    v_mfma_f32_16x16x32_bf16 v[220:223], v[12:15], v[76:79], v[220:223]
    ds_read_b128 v[12:15], v0 offset:61440
    v_cvt_pk_bf16_f32 v210, v210, v214
    v_mfma_f32_16x16x32_bf16 v[216:219], v[16:19], v[80:83], v[216:219]
    buffer_store_dword v208, v7, s[20:23], s40 offen sc0 sc1
    v_mfma_f32_16x16x32_bf16 v[220:223], v[16:19], v[84:87], v[220:223]
    ds_read_b128 v[16:19], v1 offset:61440
    v_cvt_pk_bf16_f32 v211, v211, v215
    v_mfma_f32_16x16x32_bf16 v[216:219], v[20:23], v[88:91], v[216:219]
    buffer_store_dword v209, v6, s[20:23], s40 offen sc0 sc1
    v_mfma_f32_16x16x32_bf16 v[220:223], v[20:23], v[92:95], v[220:223]
    ds_read_b128 v[20:23], v0 offset:22528
    v_mfma_f32_16x16x32_bf16 v[216:219], v[24:27], v[96:99], v[216:219]
    buffer_store_dword v210, v5, s[20:23], s40 offen sc0 sc1
    v_mfma_f32_16x16x32_bf16 v[220:223], v[24:27], v[100:103], v[220:223]
    ds_read_b128 v[24:27], v1 offset:22528
    s_waitcnt lgkmcnt(6)
    v_mfma_f32_16x16x32_bf16 v[216:219], v[28:31], v[104:107], v[216:219]
    buffer_store_dword v211, v4, s[20:23], s40 offen sc0 sc1
    v_mfma_f32_16x16x32_bf16 v[220:223], v[28:31], v[108:111], v[220:223]
    ds_read_b128 v[28:31], v3 offset:53248
    s_add_u32 s38, s40, 114688
    v_mfma_f32_16x16x32_bf16 v[216:219], v[32:35], v[112:115], v[216:219]
    v_mfma_f32_16x16x32_bf16 v[220:223], v[32:35], v[116:119], v[220:223]
    ds_read_b128 v[32:35], v2 offset:55296
    v_mfma_f32_16x16x32_bf16 v[216:219], v[36:39], v[128:131], v[216:219]
    v_mfma_f32_16x16x32_bf16 v[220:223], v[36:39], v[132:135], v[220:223]
    ds_read_b128 v[36:39], v2 offset:24576
    v_mfma_f32_16x16x32_bf16 v[224:227], v[40:43], v[120:123], v[224:227]
    v_mfma_f32_16x16x32_bf16 v[228:231], v[40:43], v[124:127], v[228:231]
    ds_read_b128 v[40:43], v3 offset:24576
    s_waitcnt lgkmcnt(6)
    v_mfma_f32_16x16x32_bf16 v[224:227], v[44:47], v[72:75], v[224:227]
    v_cvt_pk_bf16_f32 v216, v216, v220
    v_cvt_pk_bf16_f32 v217, v217, v221
    v_mfma_f32_16x16x32_bf16 v[228:231], v[44:47], v[76:79], v[228:231]
    ds_read_b128 v[44:47], v0 offset:63488
    v_cvt_pk_bf16_f32 v218, v218, v222
    v_mfma_f32_16x16x32_bf16 v[224:227], v[8:11], v[80:83], v[224:227]
    buffer_store_dword v216, v7, s[20:23], s38 offen sc0 sc1
    v_mfma_f32_16x16x32_bf16 v[228:231], v[8:11], v[84:87], v[228:231]
    ds_read_b128 v[8:11], v1 offset:63488
    v_cvt_pk_bf16_f32 v219, v219, v223
    v_mfma_f32_16x16x32_bf16 v[224:227], v[12:15], v[88:91], v[224:227]
    buffer_store_dword v217, v6, s[20:23], s38 offen sc0 sc1
    v_mfma_f32_16x16x32_bf16 v[228:231], v[12:15], v[92:95], v[228:231]
    ds_read_b128 v[12:15], v0 offset:24576
    v_mfma_f32_16x16x32_bf16 v[224:227], v[16:19], v[96:99], v[224:227]
    buffer_store_dword v218, v5, s[20:23], s38 offen sc0 sc1
    v_mfma_f32_16x16x32_bf16 v[228:231], v[16:19], v[100:103], v[228:231]
    ds_read_b128 v[16:19], v1 offset:24576
    s_waitcnt lgkmcnt(6)
    v_mfma_f32_16x16x32_bf16 v[224:227], v[20:23], v[104:107], v[224:227]
    buffer_store_dword v219, v4, s[20:23], s38 offen sc0 sc1
    v_mfma_f32_16x16x32_bf16 v[228:231], v[20:23], v[108:111], v[228:231]
    ds_read_b128 v[20:23], v3 offset:55296
    s_add_u32 s40, s38, 114688
    v_mfma_f32_16x16x32_bf16 v[224:227], v[24:27], v[112:115], v[224:227]
    v_mfma_f32_16x16x32_bf16 v[228:231], v[24:27], v[116:119], v[228:231]
    ds_read_b128 v[24:27], v2 offset:57344
    v_mfma_f32_16x16x32_bf16 v[224:227], v[28:31], v[128:131], v[224:227]
    v_mfma_f32_16x16x32_bf16 v[228:231], v[28:31], v[132:135], v[228:231]
    ds_read_b128 v[28:31], v2 offset:26624
    v_mfma_f32_16x16x32_bf16 v[232:235], v[32:35], v[120:123], v[232:235]
    v_mfma_f32_16x16x32_bf16 v[236:239], v[32:35], v[124:127], v[236:239]
    ds_read_b128 v[32:35], v3 offset:26624
    s_waitcnt lgkmcnt(6)
    v_mfma_f32_16x16x32_bf16 v[232:235], v[36:39], v[72:75], v[232:235]
    v_cvt_pk_bf16_f32 v224, v224, v228
    v_cvt_pk_bf16_f32 v225, v225, v229
    v_mfma_f32_16x16x32_bf16 v[236:239], v[36:39], v[76:79], v[236:239]
    ds_read_b128 v[36:39], v48 offset:26624
    v_cvt_pk_bf16_f32 v226, v226, v230
    v_mfma_f32_16x16x32_bf16 v[232:235], v[40:43], v[80:83], v[232:235]
    buffer_store_dword v224, v7, s[20:23], s40 offen sc0 sc1
    v_mfma_f32_16x16x32_bf16 v[236:239], v[40:43], v[84:87], v[236:239]
    ds_read_b128 v[40:43], v49 offset:26624
    v_cvt_pk_bf16_f32 v227, v227, v231
    v_mfma_f32_16x16x32_bf16 v[232:235], v[44:47], v[88:91], v[232:235]
    buffer_store_dword v225, v6, s[20:23], s40 offen sc0 sc1
    v_mfma_f32_16x16x32_bf16 v[236:239], v[44:47], v[92:95], v[236:239]
    ds_read_b128 v[44:47], v0 offset:26624
    v_mfma_f32_16x16x32_bf16 v[232:235], v[8:11], v[96:99], v[232:235]
    buffer_store_dword v226, v5, s[20:23], s40 offen sc0 sc1
    v_mfma_f32_16x16x32_bf16 v[236:239], v[8:11], v[100:103], v[236:239]
    ds_read_b128 v[8:11], v1 offset:26624
    s_waitcnt lgkmcnt(6)
    v_mfma_f32_16x16x32_bf16 v[232:235], v[12:15], v[104:107], v[232:235]
    buffer_store_dword v227, v4, s[20:23], s40 offen sc0 sc1
    v_mfma_f32_16x16x32_bf16 v[236:239], v[12:15], v[108:111], v[236:239]
    ds_read_b128 v[12:15], v3 offset:57344
    s_add_u32 s38, s40, 114688
    v_mfma_f32_16x16x32_bf16 v[232:235], v[16:19], v[112:115], v[232:235]
    v_mfma_f32_16x16x32_bf16 v[236:239], v[16:19], v[116:119], v[236:239]
    ds_read_b128 v[16:19], v2 offset:59392
    v_mfma_f32_16x16x32_bf16 v[232:235], v[20:23], v[128:131], v[232:235]
    v_mfma_f32_16x16x32_bf16 v[236:239], v[20:23], v[132:135], v[236:239]
    ds_read_b128 v[20:23], v2 offset:28672
    v_mfma_f32_16x16x32_bf16 v[240:243], v[24:27], v[120:123], v[240:243]
    v_mfma_f32_16x16x32_bf16 v[244:247], v[24:27], v[124:127], v[244:247]
    ds_read_b128 v[24:27], v3 offset:28672
    s_waitcnt lgkmcnt(6)
    v_mfma_f32_16x16x32_bf16 v[240:243], v[28:31], v[72:75], v[240:243]
    v_cvt_pk_bf16_f32 v232, v232, v236
    v_cvt_pk_bf16_f32 v233, v233, v237
    v_mfma_f32_16x16x32_bf16 v[244:247], v[28:31], v[76:79], v[244:247]
    ds_read_b128 v[28:31], v48 offset:28672
    v_cvt_pk_bf16_f32 v234, v234, v238
    v_mfma_f32_16x16x32_bf16 v[240:243], v[32:35], v[80:83], v[240:243]
    buffer_store_dword v232, v7, s[20:23], s38 offen sc0 sc1
    v_mfma_f32_16x16x32_bf16 v[244:247], v[32:35], v[84:87], v[244:247]
    ds_read_b128 v[32:35], v49 offset:28672
    v_cvt_pk_bf16_f32 v235, v235, v239
    v_mfma_f32_16x16x32_bf16 v[240:243], v[36:39], v[88:91], v[240:243]
    buffer_store_dword v233, v6, s[20:23], s38 offen sc0 sc1
    v_mfma_f32_16x16x32_bf16 v[244:247], v[36:39], v[92:95], v[244:247]
    ds_read_b128 v[36:39], v0 offset:28672
    v_mfma_f32_16x16x32_bf16 v[240:243], v[40:43], v[96:99], v[240:243]
    buffer_store_dword v234, v5, s[20:23], s38 offen sc0 sc1
    v_mfma_f32_16x16x32_bf16 v[244:247], v[40:43], v[100:103], v[244:247]
    ds_read_b128 v[40:43], v1 offset:28672
    s_waitcnt lgkmcnt(6)
    v_mfma_f32_16x16x32_bf16 v[240:243], v[44:47], v[104:107], v[240:243]
    buffer_store_dword v235, v4, s[20:23], s38 offen sc0 sc1
    v_mfma_f32_16x16x32_bf16 v[244:247], v[44:47], v[108:111], v[244:247]
    ds_read_b128 v[44:47], v3 offset:59392
    s_add_u32 s40, s38, 114688
    v_mfma_f32_16x16x32_bf16 v[240:243], v[8:11], v[112:115], v[240:243]
    v_mfma_f32_16x16x32_bf16 v[244:247], v[8:11], v[116:119], v[244:247]
    v_mfma_f32_16x16x32_bf16 v[240:243], v[12:15], v[128:131], v[240:243]
    v_mfma_f32_16x16x32_bf16 v[244:247], v[12:15], v[132:135], v[244:247]
    s_cbranch_vccz L_e14
    v_mfma_f32_16x16x32_bf16 v[248:251], v[16:19], v[120:123], v[248:251]
    v_mfma_f32_16x16x32_bf16 v[252:255], v[16:19], v[124:127], v[252:255]
    s_waitcnt lgkmcnt(3)
    v_mfma_f32_16x16x32_bf16 v[248:251], v[20:23], v[72:75], v[248:251]
    v_cvt_pk_bf16_f32 v240, v240, v244
    v_cvt_pk_bf16_f32 v241, v241, v245
    v_mfma_f32_16x16x32_bf16 v[252:255], v[20:23], v[76:79], v[252:255]
    v_cvt_pk_bf16_f32 v242, v242, v246
    v_cvt_pk_bf16_f32 v243, v243, v247
    v_mfma_f32_16x16x32_bf16 v[248:251], v[24:27], v[80:83], v[248:251]
    buffer_store_dword v240, v7, s[20:23], s40 offen sc0 sc1
    v_mfma_f32_16x16x32_bf16 v[252:255], v[24:27], v[84:87], v[252:255]
    buffer_store_dword v241, v6, s[20:23], s40 offen sc0 sc1
    v_mfma_f32_16x16x32_bf16 v[248:251], v[28:31], v[88:91], v[248:251]
    buffer_store_dword v242, v5, s[20:23], s40 offen sc0 sc1
    v_mfma_f32_16x16x32_bf16 v[252:255], v[28:31], v[92:95], v[252:255]
    buffer_store_dword v243, v4, s[20:23], s40 offen sc0 sc1
    v_mfma_f32_16x16x32_bf16 v[248:251], v[32:35], v[96:99], v[248:251]
    v_mfma_f32_16x16x32_bf16 v[252:255], v[32:35], v[100:103], v[252:255]
    s_waitcnt lgkmcnt(0)
    v_mfma_f32_16x16x32_bf16 v[248:251], v[36:39], v[104:107], v[248:251]
    v_mfma_f32_16x16x32_bf16 v[252:255], v[36:39], v[108:111], v[252:255]
    s_add_u32 s38, s40, 114688
    v_mfma_f32_16x16x32_bf16 v[248:251], v[40:43], v[112:115], v[248:251]
    v_mfma_f32_16x16x32_bf16 v[252:255], v[40:43], v[116:119], v[252:255]
    v_mfma_f32_16x16x32_bf16 v[248:251], v[44:47], v[128:131], v[248:251]
    v_mfma_f32_16x16x32_bf16 v[252:255], v[44:47], v[132:135], v[252:255]
    s_nop 7
    v_cvt_pk_bf16_f32 v248, v248, v252
    v_cvt_pk_bf16_f32 v249, v249, v253
    v_cvt_pk_bf16_f32 v250, v250, v254
    v_cvt_pk_bf16_f32 v251, v251, v255
    buffer_store_dword v248, v7, s[20:23], s38 offen sc0 sc1
    buffer_store_dword v249, v6, s[20:23], s38 offen sc0 sc1
    buffer_store_dword v250, v5, s[20:23], s38 offen sc0 sc1
    buffer_store_dword v251, v4, s[20:23], s38 offen sc0 sc1
    s_endpgm
L_e14:
    s_nop 7
    v_cvt_pk_bf16_f32 v240, v240, v244
    v_cvt_pk_bf16_f32 v241, v241, v245
    v_cvt_pk_bf16_f32 v242, v242, v246
    v_cvt_pk_bf16_f32 v243, v243, v247
    buffer_store_dword v240, v7, s[20:23], s40 offen sc0 sc1
    buffer_store_dword v241, v6, s[20:23], s40 offen sc0 sc1
    buffer_store_dword v242, v5, s[20:23], s40 offen sc0 sc1
    buffer_store_dword v243, v4, s[20:23], s40 offen sc0 sc1
    s_endpgm
    s_endpgm
.p2alignl 12, 0xbf810000
L_codeend:
.section .rodata,"a"
.p2align 6
.amdhsa_kernel standalone__weight_only_int_gptq__prompt_kernel
  .amdhsa_next_free_vgpr 256
  .amdhsa_next_free_sgpr 102
  .amdhsa_accum_offset 256
  .amdhsa_group_segment_fixed_size 0
  .amdhsa_kernarg_size 64
  .amdhsa_user_sgpr_count 2
  .amdhsa_user_sgpr_kernarg_segment_ptr 1
  .amdhsa_system_sgpr_workgroup_id_x 1
  .amdhsa_float_denorm_mode_32 3
  .amdhsa_float_denorm_mode_16_64 3
.end_amdhsa_kernel
```
